```python
import torch

def _softmax(x, axis=-1):
    return torch.softmax(x, dim=axis)
def _gelu(x):
    return torch.nn.functional.gelu(x, approximate="tanh")
def _silu(x):
    return torch.nn.functional.silu(x)
def _sigmoid(x):
    return torch.sigmoid(x)
def _layernorm(x, axis=-1, eps=1e-5):
    m = x.mean(dim=axis, keepdim=True)
    v = x.var(dim=axis, keepdim=True, unbiased=False)
    return (x - m) / torch.sqrt(v + eps)
def _scatter_add(tgt, idx, src, axis=0):
    return tgt.clone().index_add_(axis, idx, src)
def _segment_sum(src, seg, n):
    out = torch.zeros((n,) + src.shape[1:], dtype=src.dtype)
    return out.index_add_(0, seg, src)
def _pad(x, pw):
    flat = tuple(v for pair in reversed(pw) for v in pair)
    return torch.nn.functional.pad(x, flat)

kernel_name = 'recurrent_scan__mha_block_cached__dense_activation_relu__decode'

def setup_inputs():

    _w = (lambda a: (lambda t: t.to(torch.bfloat16) if t.is_floating_point() else t)(torch.as_tensor(a)))
    def _A_setup():
        B, Sq, D = 4, 1, 640
        H, Sk, Dh = 32, 4096, 192
        return {
            "x": _w((lambda *s: torch.randn(*s, dtype=torch.bfloat16) * 0.05)(B, Sq, D)),
            "k_cache": _w((lambda *s: torch.randn(*s, dtype=torch.bfloat16) * 1.6)(B, H, Sk, Dh)),
            "v_cache": _w((lambda *s: torch.randn(*s, dtype=torch.bfloat16) * 0.2)(B, H, Sk, Dh)),
            "wq": _w((lambda *s: torch.randn(*s, dtype=torch.bfloat16) * 1.6)(D, H * Dh) * (D ** -0.5)),
            "wo": _w((lambda *s: torch.randn(*s, dtype=torch.bfloat16) * 0.2)(H * Dh, D) * ((H * Dh) ** -0.5)),
        }
    _A_in = _A_setup()

    def _B_setup():
        B, S, D, Dff = 4, 1, 640, 1536
        return {
            "x": _w((lambda *s: torch.randn(*s, dtype=torch.bfloat16) * 0.05)(B, S, D)),
            "w1": _w((lambda *s: torch.randn(*s, dtype=torch.bfloat16) * 0.1)(D, Dff)),
            "w2": _w((lambda *s: torch.randn(*s, dtype=torch.bfloat16) * 0.1)(Dff, D)),
        }
    _B_in = _B_setup()

    return {
        "A_x": _A_in["x"],
        "A_k_cache": _A_in["k_cache"],
        "A_v_cache": _A_in["v_cache"],
        "A_wq": _A_in["wq"],
        "A_wo": _A_in["wo"],
        "B_x": _B_in["x"],
        "B_w1": _B_in["w1"],
        "B_w2": _B_in["w2"],
    }

def reference(A_x, A_k_cache, A_v_cache, A_wq, A_wo, B_x, B_w1, B_w2):
    def _A_ref(x, k_cache, v_cache, wq, wo):
        B, Sq, D = x.shape
        H, Dh = 32, 192
        q = (lambda x, *d: x.permute(*d))((x @ wq).reshape(B, Sq, H, Dh), 0, 2, 1, 3)
        scores = torch.einsum("bhqd,bhkd->bhqk", q, k_cache) * (Dh ** -0.5)
        p = _softmax(scores, axis=-1)
        o = torch.einsum("bhqk,bhkd->bhqd", p, v_cache)
        return (lambda x, *d: x.permute(*d))(o, 0, 2, 1, 3).reshape(B, Sq, H * Dh) @ wo

    def _B_ref(x, w1, w2):
        h = torch.einsum("bsd,df->bsf", x, w1)
        zero = torch.zeros_like(h)
        h = torch.maximum(h, zero)
        return torch.einsum("bsf,fd->bsd", h, w2)

    x = A_x
    xn = _layernorm(x, axis=-1)
    s = _A_ref(xn, A_k_cache, A_v_cache, A_wq, A_wo)
    g = _silu(_B_ref(xn, B_w1, B_w2))
    return x + s * g
```

```asm
; @launch grid=(256,1,1) block=(384,1,1) lds=122880
.amdgcn_target "amdgcn-amd-amdhsa--gfx950"
.text
.globl recurrent_scan__mha_block_cached__dense_activation_relu__decode_kernel
.p2align 8
.type recurrent_scan__mha_block_cached__dense_activation_relu__decode_kernel,@function
recurrent_scan__mha_block_cached__dense_activation_relu__decode_kernel:
    s_cmp_ge_u32 s2, 256
    s_cbranch_scc1 L_end
    s_load_dwordx16 s[4:19], s[0:1], 0
    s_load_dwordx2 s[24:25], s[0:1], 80
    s_load_dwordx4 s[20:23], s[0:1], 64
    v_lshrrev_b32 v1, 6, v0
    v_and_b32 v0, 63, v0
    s_and_b32 s69, s2, 7
    s_lshl_b32 s26, s69, 5
    v_readfirstlane_b32 s3, v1
    s_lshr_b32 s67, s2, 3
    s_or_b32 s26, s26, s67
    s_lshr_b32 s27, s26, 3
    s_and_b32 s60, s26, 7
    s_lshr_b32 s67, s60, 1
    s_and_b32 s64, s60, 1
    s_mul_i32 s65, s27, 3
    s_add_u32 s65, s65, s67
    s_and_b32 s67, s27, 3
    s_mul_i32 s69, s69, 3
    s_add_u32 s69, s69, s67
    s_cmp_lt_u32 s67, 3
    s_cselect_b32 s66, 1966080, 0
    s_cmp_lt_u32 s60, 6
    s_cselect_b32 s66, 7864320, s66
    s_cselect_b32 s65, s65, s69
    s_cselect_b32 s62, 4, 1
    s_cselect_b32 s67, 0, 96
    s_lshl_b32 s63, s65, 7
    s_add_u32 s65, s65, s67
    s_mul_i32 s62, s62, 3072
    v_lshrrev_b32 v6, 4, v0
    v_and_b32 v7, 15, v0
    s_sub_u32 s3, s3, 1
    s_cmp_lt_u32 s3, 4
    s_cbranch_scc0 L_other
    v_lshrrev_b32 v2, 3, v0
    v_mul_lo_u32 v3, v2, s62
    v_lshlrev_b32 v4, 1, v6
    v_and_b32 v5, 7, v0
    v_xor_b32 v4, v4, v5
    v_lshl_add_u32 v3, v4, 4, v3
    s_lshl2_add_u32 s67, s64, s3
    s_mul_i32 s67, s67, s62
    s_mulk_i32 s67, 80
    s_add_u32 s71, s67, s63
    s_lshl_b32 s69, s62, 3
    s_mul_i32 s68, s3, 10240
    s_add_u32 m0, s68, 16896
    s_mov_b32 s39, 0x20000
    s_mov_b32 s38, s66
    s_waitcnt lgkmcnt(0)
L_stream:
    s_cmp_lt_u32 s60, 6
    s_cselect_b32 s36, s10, s16
    s_cselect_b32 s37, s11, s17
    buffer_load_dwordx4 v3, s[36:39], s71 offen nt lds
    s_add_u32 m0, m0, 1024
    s_add_u32 s71, s71, s69
    buffer_load_dwordx4 v3, s[36:39], s71 offen nt lds
    s_add_u32 m0, m0, 1024
    s_add_u32 s71, s71, s69
    buffer_load_dwordx4 v3, s[36:39], s71 offen nt lds
    s_add_u32 m0, m0, 1024
    s_add_u32 s71, s71, s69
    buffer_load_dwordx4 v3, s[36:39], s71 offen nt lds
    s_add_u32 m0, m0, 1024
    s_add_u32 s71, s71, s69
    buffer_load_dwordx4 v3, s[36:39], s71 offen nt lds
    s_add_u32 m0, m0, 1024
    s_add_u32 s71, s71, s69
    buffer_load_dwordx4 v3, s[36:39], s71 offen nt lds
    s_add_u32 m0, m0, 1024
    s_add_u32 s71, s71, s69
    buffer_load_dwordx4 v3, s[36:39], s71 offen nt lds
    s_add_u32 m0, m0, 1024
    s_add_u32 s71, s71, s69
    buffer_load_dwordx4 v3, s[36:39], s71 offen nt lds
    s_add_u32 m0, m0, 1024
    s_add_u32 s71, s71, s69
    buffer_load_dwordx4 v3, s[36:39], s71 offen nt lds
    s_add_u32 m0, m0, 1024
    s_add_u32 s71, s71, s69
    buffer_load_dwordx4 v3, s[36:39], s71 offen nt lds
    s_branch L_stream1
L_other:
    v_mul_u32_u24 v4, 1280, v6
    v_lshl_add_u32 v4, v7, 4, v4
    s_mov_b32 s47, 0x20000
    s_mov_b32 s46, 5120
    s_waitcnt lgkmcnt(0)
    s_cmp_eq_u32 s3, 4
    s_cbranch_scc1 L_pacer
    s_mov_b32 s44, s4
    s_mov_b32 s45, s5
    buffer_load_dwordx4 v[8:11], v4, s[44:47], 0 offen offset:0
    buffer_load_dwordx4 v[12:15], v4, s[44:47], 0 offen offset:256
    buffer_load_dwordx4 v[16:19], v4, s[44:47], 0 offen offset:512
    buffer_load_dwordx4 v[20:23], v4, s[44:47], 0 offen offset:768
    buffer_load_dwordx4 v[24:27], v4, s[44:47], 0 offen offset:1024
    s_getreg_b32 s14, hwreg(HW_REG_XCC_ID, 0, 4)
    s_or_b32 s14, s14, 0x80
    v_mov_b32 v78, s14
    v_mov_b32 v79, s26
    s_mov_b64 exec, 1
    global_store_byte v79, v78, s[22:23]
    s_mov_b64 exec, 3
    v_mul_u32_u24 v96, 1966320, v0
    global_load_dwordx4 v[100:103], v96, s[24:25]
    s_mov_b64 exec, -1
    s_getpc_b64 s[80:81]
L_pc:
    s_and_b32 s67, s26, 31
    v_lshl_add_u32 v4, v0, 5, s67
    v_lshlrev_b32 v4, 7, v4
    v_min_u32 v5, L_codeend-L_pc-4, v4
    s_mov_b64 exec, 63
    global_load_dword v98, v5, s[80:81]
    s_mov_b64 exec, -1
    s_branch L_aux
L_stream1:
    s_mul_i32 s70, s27, 1572864
    s_add_u32 s28, s6, s70
    s_addc_u32 s29, s7, 0
    s_add_u32 s8, s8, s70
    s_addc_u32 s9, s9, 0
    s_mov_b32 s30, 152567808
    s_mov_b32 s31, 0x20000
    s_bfe_u32 s68, s60, 0x10000
    s_lshl_b32 s67, s68, 0
    s_bfe_u32 s68, s3, 0x10000
    s_lshl_b32 s68, s68, 1
    s_or_b32 s67, s67, s68
    v_bfe_u32 v9, v0, 3, 1
    v_lshlrev_b32 v8, 2, v9
    s_bfe_u32 s68, s60, 0x10001
    s_lshl_b32 s68, s68, 3
    s_or_b32 s67, s67, s68
    s_bfe_u32 s68, s60, 0x10002
    s_lshl_b32 s68, s68, 4
    s_or_b32 s67, s67, s68
    v_bfe_u32 v9, v0, 4, 1
    v_lshl_add_u32 v8, v9, 5, v8
    v_bfe_u32 v9, v0, 5, 1
    v_lshl_add_u32 v8, v9, 6, v8
    s_bfe_u32 s68, s3, 0x10001
    s_lshl_b32 s68, s68, 7
    s_or_b32 s67, s67, s68
    v_mul_u32_u24 v1, 384, v8
    v_lshl_add_u32 v1, v5, 4, v1
    s_lshl_b32 s68, s27, 2
    v_add_u32 v8, s68, v7
    v_and_b32 v8, 15, v8
    v_lshl_add_u32 v8, v8, 8, s67
    v_lshl_add_u32 v8, v6, 17, v8
    v_mul_u32_u24 v12, 384, v8
    s_nop 0
    v_readlane_b32 s71, v12, 0
    v_readlane_b32 s70, v12, 1
    s_mov_b32 s82, 0x3d93cd3a
    s_mov_b32 s83, 0x3fb8aa3b
    v_mov_b32 v28, 0
    v_mov_b32 v29, 0
    v_mov_b32 v30, 0
    v_mov_b32 v31, 0
    v_mov_b32 v32, 0
    v_mov_b32 v33, 0
    v_mov_b32 v34, 0
    v_mov_b32 v35, 0
    v_mov_b32 v36, 0
    v_mov_b32 v37, 0
    v_mov_b32 v38, 0
    v_mov_b32 v39, 0
    v_mov_b32 v40, 0
    v_mov_b32 v41, 0
    v_mov_b32 v42, 0
    v_mov_b32 v43, 0
    v_mov_b32 v44, 0
    v_mov_b32 v45, 0
    v_mov_b32 v46, 0
    v_mov_b32 v47, 0
    v_mov_b32 v48, 0
    v_mov_b32 v49, 0
    v_mov_b32 v50, 0
    v_mov_b32 v51, 0
    v_mov_b32 v3, 0
    v_mov_b32 v15, 0
    v_lshlrev_b32 v149, 4, v5
    s_lshl_b32 s67, s3, 11
    v_lshl_add_u32 v148, v2, 5, s67
    s_mul_i32 s67, s3, 768
    v_mov_b32 v150, 0
    v_lshl_add_u32 v14, v6, 3, s67
    v_lshl_add_u32 v14, v5, 5, v14
    s_lshl_b32 s67, s3, 2
    v_mov_b32 v13, s67
    s_mov_b32 s14, 0
    s_mov_b32 s15, 1
    s_cmp_eq_u32 s66, 1966080
    s_cselect_b32 s18, 9, 5
    s_mov_b32 s21, 11
    s_waitcnt vmcnt(9)
    buffer_load_dwordx4 v[52:55], v1, s[28:31], s71 offen offset:0 nt
    buffer_load_dwordx4 v[56:59], v1, s[28:31], s71 offen offset:128 nt
    buffer_load_dwordx4 v[60:63], v1, s[28:31], s71 offen offset:256 nt
    s_waitcnt vmcnt(12)
    buffer_load_dwordx4 v[64:67], v1, s[28:31], s70 offen offset:0 nt
    buffer_load_dwordx4 v[68:71], v1, s[28:31], s70 offen offset:128 nt
    buffer_load_dwordx4 v[72:75], v1, s[28:31], s70 offen offset:256 nt
    v_readlane_b32 s71, v12, 2
    s_nop 1
    s_waitcnt vmcnt(6) lgkmcnt(0)
    s_barrier
    s_waitcnt vmcnt(3)
    buffer_load_dwordx4 v[76:79], v1, s[28:31], s71 offen offset:0 nt
    buffer_load_dwordx4 v[80:83], v1, s[28:31], s71 offen offset:128 nt
    buffer_load_dwordx4 v[84:87], v1, s[28:31], s71 offen offset:256 nt
    v_readlane_b32 s71, v12, 3
    s_nop 3
    s_waitcnt vmcnt(3)
    buffer_load_dwordx4 v[88:91], v1, s[28:31], s71 offen offset:0 nt
    buffer_load_dwordx4 v[92:95], v1, s[28:31], s71 offen offset:128 nt
    buffer_load_dwordx4 v[96:99], v1, s[28:31], s71 offen offset:256 nt
    v_readlane_b32 s71, v12, 4
    s_nop 3
    s_waitcnt vmcnt(3)
    buffer_load_dwordx4 v[100:103], v1, s[28:31], s71 offen offset:0 nt
    buffer_load_dwordx4 v[104:107], v1, s[28:31], s71 offen offset:128 nt
    buffer_load_dwordx4 v[108:111], v1, s[28:31], s71 offen offset:256 nt
    v_readlane_b32 s71, v12, 5
    s_nop 3
    s_waitcnt vmcnt(3)
    buffer_load_dwordx4 v[112:115], v1, s[28:31], s71 offen offset:0 nt
    buffer_load_dwordx4 v[116:119], v1, s[28:31], s71 offen offset:128 nt
    buffer_load_dwordx4 v[120:123], v1, s[28:31], s71 offen offset:256 nt
    v_readlane_b32 s71, v12, 6
    s_nop 3
    s_waitcnt vmcnt(3)
    buffer_load_dwordx4 v[124:127], v1, s[28:31], s71 offen offset:0 nt
    buffer_load_dwordx4 v[128:131], v1, s[28:31], s71 offen offset:128 nt
    buffer_load_dwordx4 v[132:135], v1, s[28:31], s71 offen offset:256 nt
    v_readlane_b32 s71, v12, 7
    s_nop 3
    s_waitcnt vmcnt(3)
    buffer_load_dwordx4 v[152:155], v1, s[28:31], s71 offen offset:0 nt
    buffer_load_dwordx4 v[156:159], v1, s[28:31], s71 offen offset:128 nt
    buffer_load_dwordx4 v[160:163], v1, s[28:31], s71 offen offset:256 nt
    v_readlane_b32 s71, v12, 8
    s_nop 3
    s_waitcnt vmcnt(3)
    buffer_load_dwordx4 v[164:167], v1, s[28:31], s71 offen offset:0 nt
    buffer_load_dwordx4 v[168:171], v1, s[28:31], s71 offen offset:128 nt
    buffer_load_dwordx4 v[172:175], v1, s[28:31], s71 offen offset:256 nt
    v_readlane_b32 s71, v12, 9
    s_nop 3
    s_waitcnt vmcnt(6)
    buffer_load_dwordx4 v[176:179], v1, s[28:31], s71 offen offset:0 nt
    buffer_load_dwordx4 v[180:183], v1, s[28:31], s71 offen offset:128 nt
    buffer_load_dwordx4 v[184:187], v1, s[28:31], s71 offen offset:256 nt
    v_readlane_b32 s71, v12, 10
    s_nop 3
    s_waitcnt vmcnt(9)
    buffer_load_dwordx4 v[188:191], v1, s[28:31], s71 offen offset:0 nt
    buffer_load_dwordx4 v[192:195], v1, s[28:31], s71 offen offset:128 nt
    buffer_load_dwordx4 v[196:199], v1, s[28:31], s71 offen offset:256 nt
    v_readlane_b32 s71, v12, 11
    s_nop 3
    s_mov_b32 s40, s24
    s_mov_b32 s41, s25
    s_mov_b32 s42, 1966336
    s_mov_b32 s43, 0x20000
    s_mov_b32 s48, s12
    s_mov_b32 s49, s13
    s_mov_b32 s50, 7864320
    s_mov_b32 s51, 0x20000
    s_mul_i32 s16, s27, 245760
    s_mul_i32 s67, s60, 128
    s_add_u32 s16, s16, s67
    s_mul_i32 s67, s3, 61440
    s_add_u32 s16, s16, s67
    s_mul_i32 s17, s3, 6144
    s_add_u32 s17, s17, 57856
    v_lshrrev_b32 v2, 3, v0
    v_mul_u32_u24 v2, 1280, v2
    v_lshrrev_b32 v4, 4, v0
    v_lshlrev_b32 v4, 1, v4
    v_and_b32 v5, 7, v0
    v_xor_b32 v4, v4, v5
    v_lshl_add_u32 v200, v4, 4, v2
    s_barrier
.p2align 3
L_kbatch:
    ds_read_b128 v[16:19], v149 offset:6912
    ds_read_b128 v[20:23], v149 offset:7040
    ds_read_b128 v[24:27], v149 offset:7168
    v_add_u32 v149, 416, v149
    s_waitcnt lgkmcnt(0)
L_kloop:
    s_waitcnt lgkmcnt(0)
    v_readfirstlane_b32 s20, v15
    v_mov_b32 v2, s14
    s_sub_i32 s72, s14, s20
    s_max_i32 s72, s72, 0
    s_min_i32 s72, s72, 6
    s_lshl_b32 s68, s72, 2
    s_lshr_b32 s15, 0x3445599, s68
    s_and_b32 s15, s15, 15
    s_cmp_eq_u32 s20, 0
    s_cselect_b32 s15, s18, s15
    s_cmp_lt_u32 s14, 4
    s_cbranch_scc1 L_n_3
    s_cmp_eq_u32 s15, 5
    s_cbranch_scc0 L_y_5
    s_waitcnt vmcnt(5)
    buffer_load_dwordx4 v[136:139], v1, s[28:31], s71 offen offset:0 nt
    s_waitcnt vmcnt(5)
    buffer_load_dwordx4 v[140:143], v1, s[28:31], s71 offen offset:128 nt
    s_waitcnt vmcnt(5)
    buffer_load_dwordx4 v[144:147], v1, s[28:31], s71 offen offset:256 nt
    s_branch L_x_4
L_y_5:
    s_cmp_eq_u32 s15, 4
    s_cbranch_scc0 L_y_6
    s_waitcnt vmcnt(4)
    buffer_load_dwordx4 v[136:139], v1, s[28:31], s71 offen offset:0 nt
    s_waitcnt vmcnt(4)
    buffer_load_dwordx4 v[140:143], v1, s[28:31], s71 offen offset:128 nt
    s_waitcnt vmcnt(4)
    buffer_load_dwordx4 v[144:147], v1, s[28:31], s71 offen offset:256 nt
    s_branch L_x_4
L_y_6:
    s_cmp_eq_u32 s15, 3
    s_cbranch_scc0 L_y_7
    s_waitcnt vmcnt(3)
    buffer_load_dwordx4 v[136:139], v1, s[28:31], s71 offen offset:0 nt
    s_waitcnt vmcnt(3)
    buffer_load_dwordx4 v[140:143], v1, s[28:31], s71 offen offset:128 nt
    s_waitcnt vmcnt(3)
    buffer_load_dwordx4 v[144:147], v1, s[28:31], s71 offen offset:256 nt
    s_branch L_x_4
L_y_7:
    s_waitcnt vmcnt(6)
L_w_1:
    buffer_load_dwordx4 v[136:139], v1, s[28:31], s71 offen offset:0 nt
    buffer_load_dwordx4 v[140:143], v1, s[28:31], s71 offen offset:128 nt
    buffer_load_dwordx4 v[144:147], v1, s[28:31], s71 offen offset:256 nt
L_x_4:
    s_add_u32 s21, s21, 1
    s_and_b32 s21, s21, 63
    s_cselect_b32 s28, s28, s8
    s_cselect_b32 s29, s29, s9
    v_readlane_b32 s71, v12, s21
L_n_3:
    ds_write_b32 v13, v2 offset:8592
    s_waitcnt vmcnt(21)
L_c_2:
    v_dot2c_f32_bf16 v3, v52, v16
    v_dot2c_f32_bf16 v3, v53, v17
    v_dot2c_f32_bf16 v3, v54, v18
    v_dot2c_f32_bf16 v3, v55, v19
    v_dot2c_f32_bf16 v3, v56, v20
    v_dot2c_f32_bf16 v3, v57, v21
    v_dot2c_f32_bf16 v3, v58, v22
    v_dot2c_f32_bf16 v3, v59, v23
    v_dot2c_f32_bf16 v3, v60, v24
    v_dot2c_f32_bf16 v3, v61, v25
    v_dot2c_f32_bf16 v3, v62, v26
    v_dot2c_f32_bf16 v3, v63, v27
    s_nop 2
    v_add_f32_dpp v4, v3, v3 quad_perm:[1,0,3,2] row_mask:0xf bank_mask:0xf
    v_mov_b32 v3, 0
    s_nop 0
    v_add_f32_dpp v4, v4, v4 quad_perm:[2,3,0,1] row_mask:0xf bank_mask:0xf
    s_nop 1
    v_add_f32_dpp v4, v4, v4 row_half_mirror row_mask:0xf bank_mask:0xf
    v_cvt_pk_bf16_f32 v4, 0, v4
    v_mul_f32 v4, s82, v4
    v_cvt_pk_bf16_f32 v4, 0, v4
    v_mul_f32 v4, s83, v4
    ds_write_b32 v148, v4 offset:8704
    s_cmp_lt_u32 s14, 4
    s_cbranch_scc1 L_n_10
    s_cmp_eq_u32 s15, 5
    s_cbranch_scc0 L_y_12
    s_waitcnt vmcnt(5)
    buffer_load_dwordx4 v[52:55], v1, s[28:31], s71 offen offset:0 nt
    s_waitcnt vmcnt(5)
    buffer_load_dwordx4 v[56:59], v1, s[28:31], s71 offen offset:128 nt
    s_waitcnt vmcnt(5)
    buffer_load_dwordx4 v[60:63], v1, s[28:31], s71 offen offset:256 nt
    s_branch L_x_11
L_y_12:
    s_cmp_eq_u32 s15, 4
    s_cbranch_scc0 L_y_13
    s_waitcnt vmcnt(4)
    buffer_load_dwordx4 v[52:55], v1, s[28:31], s71 offen offset:0 nt
    s_waitcnt vmcnt(4)
    buffer_load_dwordx4 v[56:59], v1, s[28:31], s71 offen offset:128 nt
    s_waitcnt vmcnt(4)
    buffer_load_dwordx4 v[60:63], v1, s[28:31], s71 offen offset:256 nt
    s_branch L_x_11
L_y_13:
    s_cmp_eq_u32 s15, 3
    s_cbranch_scc0 L_y_14
    s_waitcnt vmcnt(3)
    buffer_load_dwordx4 v[52:55], v1, s[28:31], s71 offen offset:0 nt
    s_waitcnt vmcnt(3)
    buffer_load_dwordx4 v[56:59], v1, s[28:31], s71 offen offset:128 nt
    s_waitcnt vmcnt(3)
    buffer_load_dwordx4 v[60:63], v1, s[28:31], s71 offen offset:256 nt
    s_branch L_x_11
L_y_14:
    s_waitcnt vmcnt(6)
L_w_8:
    buffer_load_dwordx4 v[52:55], v1, s[28:31], s71 offen offset:0 nt
    buffer_load_dwordx4 v[56:59], v1, s[28:31], s71 offen offset:128 nt
    buffer_load_dwordx4 v[60:63], v1, s[28:31], s71 offen offset:256 nt
L_x_11:
    s_add_u32 s21, s21, 1
    s_and_b32 s21, s21, 63
    v_readlane_b32 s71, v12, s21
L_n_10:
    s_waitcnt vmcnt(21)
L_c_9:
    ds_read_b32 v15, v13 offset:8576
    s_add_u32 s14, s14, 1
    v_dot2c_f32_bf16 v3, v64, v16
    v_dot2c_f32_bf16 v3, v65, v17
    v_dot2c_f32_bf16 v3, v66, v18
    v_dot2c_f32_bf16 v3, v67, v19
    v_dot2c_f32_bf16 v3, v68, v20
    v_dot2c_f32_bf16 v3, v69, v21
    v_dot2c_f32_bf16 v3, v70, v22
    v_dot2c_f32_bf16 v3, v71, v23
    v_dot2c_f32_bf16 v3, v72, v24
    v_dot2c_f32_bf16 v3, v73, v25
    v_dot2c_f32_bf16 v3, v74, v26
    v_dot2c_f32_bf16 v3, v75, v27
    s_nop 2
    v_add_f32_dpp v4, v3, v3 quad_perm:[1,0,3,2] row_mask:0xf bank_mask:0xf
    v_mov_b32 v3, 0
    s_nop 0
    v_add_f32_dpp v4, v4, v4 quad_perm:[2,3,0,1] row_mask:0xf bank_mask:0xf
    s_nop 1
    v_add_f32_dpp v4, v4, v4 row_half_mirror row_mask:0xf bank_mask:0xf
    v_cvt_pk_bf16_f32 v4, 0, v4
    v_mul_f32 v4, s82, v4
    v_cvt_pk_bf16_f32 v4, 0, v4
    v_mul_f32 v4, s83, v4
    ds_write_b32 v148, v4 offset:8708
    s_waitcnt lgkmcnt(0)
    v_readfirstlane_b32 s20, v15
    v_mov_b32 v2, s14
    s_sub_i32 s72, s14, s20
    s_max_i32 s72, s72, 0
    s_min_i32 s72, s72, 6
    s_lshl_b32 s68, s72, 2
    s_lshr_b32 s15, 0x3445599, s68
    s_and_b32 s15, s15, 15
    s_cmp_eq_u32 s20, 0
    s_cselect_b32 s15, s18, s15
    s_cmp_lt_u32 s14, 4
    s_cbranch_scc1 L_n_17
    s_cmp_eq_u32 s15, 5
    s_cbranch_scc0 L_y_19
    s_waitcnt vmcnt(5)
    buffer_load_dwordx4 v[64:67], v1, s[28:31], s71 offen offset:0 nt
    s_waitcnt vmcnt(5)
    buffer_load_dwordx4 v[68:71], v1, s[28:31], s71 offen offset:128 nt
    s_waitcnt vmcnt(5)
    buffer_load_dwordx4 v[72:75], v1, s[28:31], s71 offen offset:256 nt
    s_branch L_x_18
L_y_19:
    s_cmp_eq_u32 s15, 4
    s_cbranch_scc0 L_y_20
    s_waitcnt vmcnt(4)
    buffer_load_dwordx4 v[64:67], v1, s[28:31], s71 offen offset:0 nt
    s_waitcnt vmcnt(4)
    buffer_load_dwordx4 v[68:71], v1, s[28:31], s71 offen offset:128 nt
    s_waitcnt vmcnt(4)
    buffer_load_dwordx4 v[72:75], v1, s[28:31], s71 offen offset:256 nt
    s_branch L_x_18
L_y_20:
    s_cmp_eq_u32 s15, 3
    s_cbranch_scc0 L_y_21
    s_waitcnt vmcnt(3)
    buffer_load_dwordx4 v[64:67], v1, s[28:31], s71 offen offset:0 nt
    s_waitcnt vmcnt(3)
    buffer_load_dwordx4 v[68:71], v1, s[28:31], s71 offen offset:128 nt
    s_waitcnt vmcnt(3)
    buffer_load_dwordx4 v[72:75], v1, s[28:31], s71 offen offset:256 nt
    s_branch L_x_18
L_y_21:
    s_waitcnt vmcnt(6)
L_w_15:
    buffer_load_dwordx4 v[64:67], v1, s[28:31], s71 offen offset:0 nt
    buffer_load_dwordx4 v[68:71], v1, s[28:31], s71 offen offset:128 nt
    buffer_load_dwordx4 v[72:75], v1, s[28:31], s71 offen offset:256 nt
L_x_18:
    s_add_u32 s21, s21, 1
    s_and_b32 s21, s21, 63
    v_readlane_b32 s71, v12, s21
L_n_17:
    ds_write_b32 v13, v2 offset:8592
    s_waitcnt vmcnt(21)
L_c_16:
    v_dot2c_f32_bf16 v3, v76, v16
    v_dot2c_f32_bf16 v3, v77, v17
    v_dot2c_f32_bf16 v3, v78, v18
    v_dot2c_f32_bf16 v3, v79, v19
    v_dot2c_f32_bf16 v3, v80, v20
    v_dot2c_f32_bf16 v3, v81, v21
    v_dot2c_f32_bf16 v3, v82, v22
    v_dot2c_f32_bf16 v3, v83, v23
    v_dot2c_f32_bf16 v3, v84, v24
    v_dot2c_f32_bf16 v3, v85, v25
    v_dot2c_f32_bf16 v3, v86, v26
    v_dot2c_f32_bf16 v3, v87, v27
    s_nop 2
    v_add_f32_dpp v4, v3, v3 quad_perm:[1,0,3,2] row_mask:0xf bank_mask:0xf
    v_mov_b32 v3, 0
    s_nop 0
    v_add_f32_dpp v4, v4, v4 quad_perm:[2,3,0,1] row_mask:0xf bank_mask:0xf
    s_nop 1
    v_add_f32_dpp v4, v4, v4 row_half_mirror row_mask:0xf bank_mask:0xf
    v_cvt_pk_bf16_f32 v4, 0, v4
    v_mul_f32 v4, s82, v4
    v_cvt_pk_bf16_f32 v4, 0, v4
    v_mul_f32 v4, s83, v4
    ds_write_b32 v148, v4 offset:8712
    s_cmp_lt_u32 s14, 4
    s_cbranch_scc1 L_n_24
    s_cmp_eq_u32 s15, 5
    s_cbranch_scc0 L_y_26
    s_waitcnt vmcnt(5)
    buffer_load_dwordx4 v[76:79], v1, s[28:31], s71 offen offset:0 nt
    s_waitcnt vmcnt(5)
    buffer_load_dwordx4 v[80:83], v1, s[28:31], s71 offen offset:128 nt
    s_waitcnt vmcnt(5)
    buffer_load_dwordx4 v[84:87], v1, s[28:31], s71 offen offset:256 nt
    s_branch L_x_25
L_y_26:
    s_cmp_eq_u32 s15, 4
    s_cbranch_scc0 L_y_27
    s_waitcnt vmcnt(4)
    buffer_load_dwordx4 v[76:79], v1, s[28:31], s71 offen offset:0 nt
    s_waitcnt vmcnt(4)
    buffer_load_dwordx4 v[80:83], v1, s[28:31], s71 offen offset:128 nt
    s_waitcnt vmcnt(4)
    buffer_load_dwordx4 v[84:87], v1, s[28:31], s71 offen offset:256 nt
    s_branch L_x_25
L_y_27:
    s_cmp_eq_u32 s15, 3
    s_cbranch_scc0 L_y_28
    s_waitcnt vmcnt(3)
    buffer_load_dwordx4 v[76:79], v1, s[28:31], s71 offen offset:0 nt
    s_waitcnt vmcnt(3)
    buffer_load_dwordx4 v[80:83], v1, s[28:31], s71 offen offset:128 nt
    s_waitcnt vmcnt(3)
    buffer_load_dwordx4 v[84:87], v1, s[28:31], s71 offen offset:256 nt
    s_branch L_x_25
L_y_28:
    s_waitcnt vmcnt(6)
L_w_22:
    buffer_load_dwordx4 v[76:79], v1, s[28:31], s71 offen offset:0 nt
    buffer_load_dwordx4 v[80:83], v1, s[28:31], s71 offen offset:128 nt
    buffer_load_dwordx4 v[84:87], v1, s[28:31], s71 offen offset:256 nt
L_x_25:
    s_add_u32 s21, s21, 1
    s_and_b32 s21, s21, 63
    v_readlane_b32 s71, v12, s21
L_n_24:
    s_waitcnt vmcnt(21)
L_c_23:
    ds_read_b32 v15, v13 offset:8576
    s_add_u32 s14, s14, 1
    v_dot2c_f32_bf16 v3, v88, v16
    v_dot2c_f32_bf16 v3, v89, v17
    v_dot2c_f32_bf16 v3, v90, v18
    v_dot2c_f32_bf16 v3, v91, v19
    v_dot2c_f32_bf16 v3, v92, v20
    v_dot2c_f32_bf16 v3, v93, v21
    v_dot2c_f32_bf16 v3, v94, v22
    v_dot2c_f32_bf16 v3, v95, v23
    v_dot2c_f32_bf16 v3, v96, v24
    v_dot2c_f32_bf16 v3, v97, v25
    v_dot2c_f32_bf16 v3, v98, v26
    v_dot2c_f32_bf16 v3, v99, v27
    s_nop 2
    v_add_f32_dpp v4, v3, v3 quad_perm:[1,0,3,2] row_mask:0xf bank_mask:0xf
    v_mov_b32 v3, 0
    s_nop 0
    v_add_f32_dpp v4, v4, v4 quad_perm:[2,3,0,1] row_mask:0xf bank_mask:0xf
    s_nop 1
    v_add_f32_dpp v4, v4, v4 row_half_mirror row_mask:0xf bank_mask:0xf
    v_cvt_pk_bf16_f32 v4, 0, v4
    v_mul_f32 v4, s82, v4
    v_cvt_pk_bf16_f32 v4, 0, v4
    v_mul_f32 v4, s83, v4
    ds_write_b32 v148, v4 offset:8716
    s_waitcnt lgkmcnt(0)
    v_readfirstlane_b32 s20, v15
    v_mov_b32 v2, s14
    s_sub_i32 s72, s14, s20
    s_max_i32 s72, s72, 0
    s_min_i32 s72, s72, 6
    s_lshl_b32 s68, s72, 2
    s_lshr_b32 s15, 0x3445599, s68
    s_and_b32 s15, s15, 15
    s_cmp_eq_u32 s20, 0
    s_cselect_b32 s15, s18, s15
    s_cmp_eq_u32 s15, 5
    s_cbranch_scc0 L_y_33
    s_waitcnt vmcnt(5)
    buffer_load_dwordx4 v[88:91], v1, s[28:31], s71 offen offset:0 nt
    s_waitcnt vmcnt(5)
    buffer_load_dwordx4 v[92:95], v1, s[28:31], s71 offen offset:128 nt
    s_waitcnt vmcnt(5)
    buffer_load_dwordx4 v[96:99], v1, s[28:31], s71 offen offset:256 nt
    s_branch L_x_32
L_y_33:
    s_cmp_eq_u32 s15, 4
    s_cbranch_scc0 L_y_34
    s_waitcnt vmcnt(4)
    buffer_load_dwordx4 v[88:91], v1, s[28:31], s71 offen offset:0 nt
    s_waitcnt vmcnt(4)
    buffer_load_dwordx4 v[92:95], v1, s[28:31], s71 offen offset:128 nt
    s_waitcnt vmcnt(4)
    buffer_load_dwordx4 v[96:99], v1, s[28:31], s71 offen offset:256 nt
    s_branch L_x_32
L_y_34:
    s_cmp_eq_u32 s15, 3
    s_cbranch_scc0 L_y_35
    s_waitcnt vmcnt(3)
    buffer_load_dwordx4 v[88:91], v1, s[28:31], s71 offen offset:0 nt
    s_waitcnt vmcnt(3)
    buffer_load_dwordx4 v[92:95], v1, s[28:31], s71 offen offset:128 nt
    s_waitcnt vmcnt(3)
    buffer_load_dwordx4 v[96:99], v1, s[28:31], s71 offen offset:256 nt
    s_branch L_x_32
L_y_35:
    s_waitcnt vmcnt(6)
L_w_29:
    buffer_load_dwordx4 v[88:91], v1, s[28:31], s71 offen offset:0 nt
    buffer_load_dwordx4 v[92:95], v1, s[28:31], s71 offen offset:128 nt
    buffer_load_dwordx4 v[96:99], v1, s[28:31], s71 offen offset:256 nt
L_x_32:
    s_add_u32 s21, s21, 1
    s_and_b32 s21, s21, 63
    v_readlane_b32 s71, v12, s21
    ds_write_b32 v13, v2 offset:8592
    s_waitcnt vmcnt(21)
L_c_30:
    v_dot2c_f32_bf16 v3, v100, v16
    v_dot2c_f32_bf16 v3, v101, v17
    v_dot2c_f32_bf16 v3, v102, v18
    v_dot2c_f32_bf16 v3, v103, v19
    v_dot2c_f32_bf16 v3, v104, v20
    v_dot2c_f32_bf16 v3, v105, v21
    v_dot2c_f32_bf16 v3, v106, v22
    v_dot2c_f32_bf16 v3, v107, v23
    v_dot2c_f32_bf16 v3, v108, v24
    v_dot2c_f32_bf16 v3, v109, v25
    v_dot2c_f32_bf16 v3, v110, v26
    v_dot2c_f32_bf16 v3, v111, v27
    s_nop 2
    v_add_f32_dpp v4, v3, v3 quad_perm:[1,0,3,2] row_mask:0xf bank_mask:0xf
    v_mov_b32 v3, 0
    s_nop 0
    v_add_f32_dpp v4, v4, v4 quad_perm:[2,3,0,1] row_mask:0xf bank_mask:0xf
    s_nop 1
    v_add_f32_dpp v4, v4, v4 row_half_mirror row_mask:0xf bank_mask:0xf
    v_cvt_pk_bf16_f32 v4, 0, v4
    v_mul_f32 v4, s82, v4
    v_cvt_pk_bf16_f32 v4, 0, v4
    v_mul_f32 v4, s83, v4
    ds_write_b32 v148, v4 offset:8720
    s_cmp_eq_u32 s15, 5
    s_cbranch_scc0 L_y_40
    s_waitcnt vmcnt(5)
    buffer_load_dwordx4 v[100:103], v1, s[28:31], s71 offen offset:0 nt
    s_waitcnt vmcnt(5)
    buffer_load_dwordx4 v[104:107], v1, s[28:31], s71 offen offset:128 nt
    s_waitcnt vmcnt(5)
    buffer_load_dwordx4 v[108:111], v1, s[28:31], s71 offen offset:256 nt
    s_branch L_x_39
L_y_40:
    s_cmp_eq_u32 s15, 4
    s_cbranch_scc0 L_y_41
    s_waitcnt vmcnt(4)
    buffer_load_dwordx4 v[100:103], v1, s[28:31], s71 offen offset:0 nt
    s_waitcnt vmcnt(4)
    buffer_load_dwordx4 v[104:107], v1, s[28:31], s71 offen offset:128 nt
    s_waitcnt vmcnt(4)
    buffer_load_dwordx4 v[108:111], v1, s[28:31], s71 offen offset:256 nt
    s_branch L_x_39
L_y_41:
    s_cmp_eq_u32 s15, 3
    s_cbranch_scc0 L_y_42
    s_waitcnt vmcnt(3)
    buffer_load_dwordx4 v[100:103], v1, s[28:31], s71 offen offset:0 nt
    s_waitcnt vmcnt(3)
    buffer_load_dwordx4 v[104:107], v1, s[28:31], s71 offen offset:128 nt
    s_waitcnt vmcnt(3)
    buffer_load_dwordx4 v[108:111], v1, s[28:31], s71 offen offset:256 nt
    s_branch L_x_39
L_y_42:
    s_waitcnt vmcnt(6)
L_w_36:
    buffer_load_dwordx4 v[100:103], v1, s[28:31], s71 offen offset:0 nt
    buffer_load_dwordx4 v[104:107], v1, s[28:31], s71 offen offset:128 nt
    buffer_load_dwordx4 v[108:111], v1, s[28:31], s71 offen offset:256 nt
L_x_39:
    s_add_u32 s21, s21, 1
    s_and_b32 s21, s21, 63
    v_readlane_b32 s71, v12, s21
    s_waitcnt vmcnt(21)
L_c_37:
    ds_read_b32 v15, v13 offset:8576
    s_add_u32 s14, s14, 1
    v_dot2c_f32_bf16 v3, v112, v16
    v_dot2c_f32_bf16 v3, v113, v17
    v_dot2c_f32_bf16 v3, v114, v18
    v_dot2c_f32_bf16 v3, v115, v19
    v_dot2c_f32_bf16 v3, v116, v20
    v_dot2c_f32_bf16 v3, v117, v21
    v_dot2c_f32_bf16 v3, v118, v22
    v_dot2c_f32_bf16 v3, v119, v23
    v_dot2c_f32_bf16 v3, v120, v24
    v_dot2c_f32_bf16 v3, v121, v25
    v_dot2c_f32_bf16 v3, v122, v26
    v_dot2c_f32_bf16 v3, v123, v27
    s_nop 2
    v_add_f32_dpp v4, v3, v3 quad_perm:[1,0,3,2] row_mask:0xf bank_mask:0xf
    v_mov_b32 v3, 0
    s_nop 0
    v_add_f32_dpp v4, v4, v4 quad_perm:[2,3,0,1] row_mask:0xf bank_mask:0xf
    s_nop 1
    v_add_f32_dpp v4, v4, v4 row_half_mirror row_mask:0xf bank_mask:0xf
    v_cvt_pk_bf16_f32 v4, 0, v4
    v_mul_f32 v4, s82, v4
    v_cvt_pk_bf16_f32 v4, 0, v4
    v_mul_f32 v4, s83, v4
    ds_write_b32 v148, v4 offset:8724
    s_waitcnt lgkmcnt(0)
    v_readfirstlane_b32 s20, v15
    v_mov_b32 v2, s14
    s_sub_i32 s72, s14, s20
    s_max_i32 s72, s72, 0
    s_min_i32 s72, s72, 6
    s_lshl_b32 s68, s72, 2
    s_lshr_b32 s15, 0x3445599, s68
    s_and_b32 s15, s15, 15
    s_cmp_eq_u32 s20, 0
    s_cselect_b32 s15, s18, s15
    s_cmp_eq_u32 s15, 5
    s_cbranch_scc0 L_y_47
    s_waitcnt vmcnt(5)
    buffer_load_dwordx4 v[112:115], v1, s[28:31], s71 offen offset:0 nt
    s_waitcnt vmcnt(5)
    buffer_load_dwordx4 v[116:119], v1, s[28:31], s71 offen offset:128 nt
    s_waitcnt vmcnt(5)
    buffer_load_dwordx4 v[120:123], v1, s[28:31], s71 offen offset:256 nt
    s_branch L_x_46
L_y_47:
    s_cmp_eq_u32 s15, 4
    s_cbranch_scc0 L_y_48
    s_waitcnt vmcnt(4)
    buffer_load_dwordx4 v[112:115], v1, s[28:31], s71 offen offset:0 nt
    s_waitcnt vmcnt(4)
    buffer_load_dwordx4 v[116:119], v1, s[28:31], s71 offen offset:128 nt
    s_waitcnt vmcnt(4)
    buffer_load_dwordx4 v[120:123], v1, s[28:31], s71 offen offset:256 nt
    s_branch L_x_46
L_y_48:
    s_cmp_eq_u32 s15, 3
    s_cbranch_scc0 L_y_49
    s_waitcnt vmcnt(3)
    buffer_load_dwordx4 v[112:115], v1, s[28:31], s71 offen offset:0 nt
    s_waitcnt vmcnt(3)
    buffer_load_dwordx4 v[116:119], v1, s[28:31], s71 offen offset:128 nt
    s_waitcnt vmcnt(3)
    buffer_load_dwordx4 v[120:123], v1, s[28:31], s71 offen offset:256 nt
    s_branch L_x_46
L_y_49:
    s_waitcnt vmcnt(6)
L_w_43:
    buffer_load_dwordx4 v[112:115], v1, s[28:31], s71 offen offset:0 nt
    buffer_load_dwordx4 v[116:119], v1, s[28:31], s71 offen offset:128 nt
    buffer_load_dwordx4 v[120:123], v1, s[28:31], s71 offen offset:256 nt
L_x_46:
    s_add_u32 s21, s21, 1
    s_and_b32 s21, s21, 63
    v_readlane_b32 s71, v12, s21
    ds_write_b32 v13, v2 offset:8592
    s_waitcnt vmcnt(21)
L_c_44:
    v_dot2c_f32_bf16 v3, v124, v16
    v_dot2c_f32_bf16 v3, v125, v17
    v_dot2c_f32_bf16 v3, v126, v18
    v_dot2c_f32_bf16 v3, v127, v19
    v_dot2c_f32_bf16 v3, v128, v20
    v_dot2c_f32_bf16 v3, v129, v21
    v_dot2c_f32_bf16 v3, v130, v22
    v_dot2c_f32_bf16 v3, v131, v23
    v_dot2c_f32_bf16 v3, v132, v24
    v_dot2c_f32_bf16 v3, v133, v25
    v_dot2c_f32_bf16 v3, v134, v26
    v_dot2c_f32_bf16 v3, v135, v27
    s_nop 2
    v_add_f32_dpp v4, v3, v3 quad_perm:[1,0,3,2] row_mask:0xf bank_mask:0xf
    v_mov_b32 v3, 0
    s_nop 0
    v_add_f32_dpp v4, v4, v4 quad_perm:[2,3,0,1] row_mask:0xf bank_mask:0xf
    s_nop 1
    v_add_f32_dpp v4, v4, v4 row_half_mirror row_mask:0xf bank_mask:0xf
    v_cvt_pk_bf16_f32 v4, 0, v4
    v_mul_f32 v4, s82, v4
    v_cvt_pk_bf16_f32 v4, 0, v4
    v_mul_f32 v4, s83, v4
    ds_write_b32 v148, v4 offset:8728
    s_cmp_lt_u32 s14, 4
    s_cbranch_scc0 L_nospare
    s_waitcnt vmcnt(9)
    v_mov_b32 v136, v152
    v_mov_b32 v137, v153
    v_mov_b32 v138, v154
    v_mov_b32 v139, v155
    v_mov_b32 v140, v156
    v_mov_b32 v141, v157
    v_mov_b32 v142, v158
    v_mov_b32 v143, v159
    v_mov_b32 v144, v160
    v_mov_b32 v145, v161
    v_mov_b32 v146, v162
    v_mov_b32 v147, v163
    v_mov_b32 v52, v164
    v_mov_b32 v53, v165
    v_mov_b32 v54, v166
    v_mov_b32 v55, v167
    v_mov_b32 v56, v168
    v_mov_b32 v57, v169
    v_mov_b32 v58, v170
    v_mov_b32 v59, v171
    v_mov_b32 v60, v172
    v_mov_b32 v61, v173
    v_mov_b32 v62, v174
    v_mov_b32 v63, v175
    v_mov_b32 v64, v176
    v_mov_b32 v65, v177
    v_mov_b32 v66, v178
    v_mov_b32 v67, v179
    v_mov_b32 v68, v180
    v_mov_b32 v69, v181
    v_mov_b32 v70, v182
    v_mov_b32 v71, v183
    v_mov_b32 v72, v184
    v_mov_b32 v73, v185
    v_mov_b32 v74, v186
    v_mov_b32 v75, v187
    v_mov_b32 v76, v188
    v_mov_b32 v77, v189
    v_mov_b32 v78, v190
    v_mov_b32 v79, v191
    v_mov_b32 v80, v192
    v_mov_b32 v81, v193
    v_mov_b32 v82, v194
    v_mov_b32 v83, v195
    v_mov_b32 v84, v196
    v_mov_b32 v85, v197
    v_mov_b32 v86, v198
    v_mov_b32 v87, v199
L_nospare:
    s_cmp_eq_u32 s15, 5
    s_cbranch_scc0 L_y_54
    s_waitcnt vmcnt(5)
    buffer_load_dwordx4 v[124:127], v1, s[28:31], s71 offen offset:0 nt
    s_waitcnt vmcnt(5)
    buffer_load_dwordx4 v[128:131], v1, s[28:31], s71 offen offset:128 nt
    s_waitcnt vmcnt(5)
    buffer_load_dwordx4 v[132:135], v1, s[28:31], s71 offen offset:256 nt
    s_branch L_x_53
L_y_54:
    s_cmp_eq_u32 s15, 4
    s_cbranch_scc0 L_y_55
    s_waitcnt vmcnt(4)
    buffer_load_dwordx4 v[124:127], v1, s[28:31], s71 offen offset:0 nt
    s_waitcnt vmcnt(4)
    buffer_load_dwordx4 v[128:131], v1, s[28:31], s71 offen offset:128 nt
    s_waitcnt vmcnt(4)
    buffer_load_dwordx4 v[132:135], v1, s[28:31], s71 offen offset:256 nt
    s_branch L_x_53
L_y_55:
    s_cmp_eq_u32 s15, 3
    s_cbranch_scc0 L_y_56
    s_waitcnt vmcnt(3)
    buffer_load_dwordx4 v[124:127], v1, s[28:31], s71 offen offset:0 nt
    s_waitcnt vmcnt(3)
    buffer_load_dwordx4 v[128:131], v1, s[28:31], s71 offen offset:128 nt
    s_waitcnt vmcnt(3)
    buffer_load_dwordx4 v[132:135], v1, s[28:31], s71 offen offset:256 nt
    s_branch L_x_53
L_y_56:
    s_waitcnt vmcnt(6)
L_w_50:
    buffer_load_dwordx4 v[124:127], v1, s[28:31], s71 offen offset:0 nt
    buffer_load_dwordx4 v[128:131], v1, s[28:31], s71 offen offset:128 nt
    buffer_load_dwordx4 v[132:135], v1, s[28:31], s71 offen offset:256 nt
L_x_53:
    s_add_u32 s21, s21, 1
    s_and_b32 s21, s21, 63
    v_readlane_b32 s71, v12, s21
    s_waitcnt vmcnt(21)
L_c_51:
    ds_read_b32 v15, v13 offset:8576
    s_add_u32 s14, s14, 1
    v_dot2c_f32_bf16 v3, v136, v16
    v_dot2c_f32_bf16 v3, v137, v17
    v_dot2c_f32_bf16 v3, v138, v18
    v_dot2c_f32_bf16 v3, v139, v19
    v_dot2c_f32_bf16 v3, v140, v20
    v_dot2c_f32_bf16 v3, v141, v21
    v_dot2c_f32_bf16 v3, v142, v22
    v_dot2c_f32_bf16 v3, v143, v23
    v_dot2c_f32_bf16 v3, v144, v24
    v_dot2c_f32_bf16 v3, v145, v25
    v_dot2c_f32_bf16 v3, v146, v26
    v_dot2c_f32_bf16 v3, v147, v27
    s_nop 2
    v_add_f32_dpp v4, v3, v3 quad_perm:[1,0,3,2] row_mask:0xf bank_mask:0xf
    v_mov_b32 v3, 0
    s_nop 0
    v_add_f32_dpp v4, v4, v4 quad_perm:[2,3,0,1] row_mask:0xf bank_mask:0xf
    s_nop 1
    v_add_f32_dpp v4, v4, v4 row_half_mirror row_mask:0xf bank_mask:0xf
    v_cvt_pk_bf16_f32 v4, 0, v4
    v_mul_f32 v4, s82, v4
    v_cvt_pk_bf16_f32 v4, 0, v4
    v_mul_f32 v4, s83, v4
    ds_write_b32 v148, v4 offset:8732
    v_add_u32 v148, 256, v148
    s_bitcmp1_b32 s14, 2
    s_cbranch_scc1 L_kloop
    s_cmp_lt_u32 s14, 32
    s_cbranch_scc1 L_kbatch
    v_subrev_u32 v148, 2048, v148
.p2align 3
L_vbatch:
    ds_read_b128 v[8:11], v150 offset:8608
    s_waitcnt lgkmcnt(0)
    v_cmp_eq_u32 vcc, 0, v10
    s_cbranch_vccnz L_vbatch
    v_add_u32 v150, 16, v150
L_vloop:
    ds_read_b128 v[16:19], v148 offset:8704
    ds_read_b128 v[20:23], v148 offset:8720
    v_add_u32 v148, 256, v148
    s_waitcnt lgkmcnt(0)
    v_sub_f32 v5, v16, v8
    v_sub_f32 v5, v5, v9
    v_exp_f32 v5, v5
    s_nop 0
    v_cvt_pk_bf16_f32 v6, v5, 0
    v_cvt_pk_bf16_f32 v7, 0, v5
    s_waitcnt lgkmcnt(0)
    v_readfirstlane_b32 s20, v15
    v_mov_b32 v2, s14
    s_sub_i32 s72, s14, s20
    s_max_i32 s72, s72, 0
    s_min_i32 s72, s72, 6
    s_lshl_b32 s68, s72, 2
    s_mov_b32 s15, 0x3445599
    s_cmp_ge_u32 s14, 50
    s_cselect_b32 s15, 0x3344599, s15
    s_lshr_b32 s15, s15, s68
    s_and_b32 s15, s15, 15
    s_cmp_eq_u32 s20, 0
    s_cselect_b32 s15, s18, s15
    s_cmp_ge_u32 s14, 60
    s_cselect_b32 s15, 10, s15
    s_cmp_eq_u32 s15, 5
    s_cbranch_scc0 L_y_61
    s_waitcnt vmcnt(5)
    buffer_load_dwordx4 v[136:139], v1, s[28:31], s71 offen offset:0 nt
    s_waitcnt vmcnt(5)
    buffer_load_dwordx4 v[140:143], v1, s[28:31], s71 offen offset:128 nt
    s_waitcnt vmcnt(5)
    buffer_load_dwordx4 v[144:147], v1, s[28:31], s71 offen offset:256 nt
    s_branch L_x_60
L_y_61:
    s_cmp_eq_u32 s15, 4
    s_cbranch_scc0 L_y_62
    s_waitcnt vmcnt(4)
    buffer_load_dwordx4 v[136:139], v1, s[28:31], s71 offen offset:0 nt
    s_waitcnt vmcnt(4)
    buffer_load_dwordx4 v[140:143], v1, s[28:31], s71 offen offset:128 nt
    s_waitcnt vmcnt(4)
    buffer_load_dwordx4 v[144:147], v1, s[28:31], s71 offen offset:256 nt
    s_branch L_x_60
L_y_62:
    s_cmp_eq_u32 s15, 3
    s_cbranch_scc0 L_y_63
    s_waitcnt vmcnt(3)
    buffer_load_dwordx4 v[136:139], v1, s[28:31], s71 offen offset:0 nt
    s_waitcnt vmcnt(3)
    buffer_load_dwordx4 v[140:143], v1, s[28:31], s71 offen offset:128 nt
    s_waitcnt vmcnt(3)
    buffer_load_dwordx4 v[144:147], v1, s[28:31], s71 offen offset:256 nt
    s_branch L_x_60
L_y_63:
    s_cmp_eq_u32 s15, 10
    s_cbranch_scc1 L_w_57
    s_waitcnt vmcnt(6)
L_w_57:
    buffer_load_dwordx4 v[136:139], v1, s[28:31], s71 offen offset:0 nt
    buffer_load_dwordx4 v[140:143], v1, s[28:31], s71 offen offset:128 nt
    buffer_load_dwordx4 v[144:147], v1, s[28:31], s71 offen offset:256 nt
L_x_60:
    s_add_u32 s21, s21, 1
    s_and_b32 s21, s21, 63
    v_readlane_b32 s71, v12, s21
    ds_write_b32 v13, v2 offset:8592
    s_waitcnt vmcnt(21)
L_c_58:
    v_dot2c_f32_bf16 v28, v52, v6
    v_dot2c_f32_bf16 v29, v52, v7
    v_dot2c_f32_bf16 v30, v53, v6
    v_dot2c_f32_bf16 v31, v53, v7
    v_dot2c_f32_bf16 v32, v54, v6
    v_dot2c_f32_bf16 v33, v54, v7
    v_dot2c_f32_bf16 v34, v55, v6
    v_dot2c_f32_bf16 v35, v55, v7
    v_dot2c_f32_bf16 v36, v56, v6
    v_dot2c_f32_bf16 v37, v56, v7
    v_dot2c_f32_bf16 v38, v57, v6
    v_dot2c_f32_bf16 v39, v57, v7
    v_dot2c_f32_bf16 v40, v58, v6
    v_dot2c_f32_bf16 v41, v58, v7
    v_dot2c_f32_bf16 v42, v59, v6
    v_dot2c_f32_bf16 v43, v59, v7
    v_dot2c_f32_bf16 v44, v60, v6
    v_dot2c_f32_bf16 v45, v60, v7
    v_dot2c_f32_bf16 v46, v61, v6
    v_dot2c_f32_bf16 v47, v61, v7
    v_dot2c_f32_bf16 v48, v62, v6
    v_dot2c_f32_bf16 v49, v62, v7
    v_dot2c_f32_bf16 v50, v63, v6
    v_dot2c_f32_bf16 v51, v63, v7
    v_sub_f32 v5, v17, v8
    v_sub_f32 v5, v5, v9
    v_exp_f32 v5, v5
    s_nop 0
    v_cvt_pk_bf16_f32 v6, v5, 0
    v_cvt_pk_bf16_f32 v7, 0, v5
    s_cmp_ge_u32 s14, 60
    s_cbranch_scc0 L_n_66
    s_waitcnt vmcnt(18)
    s_branch L_c_65
L_n_66:
    s_cmp_eq_u32 s15, 5
    s_cbranch_scc0 L_y_68
    s_waitcnt vmcnt(5)
    buffer_load_dwordx4 v[52:55], v1, s[28:31], s71 offen offset:0 nt
    s_waitcnt vmcnt(5)
    buffer_load_dwordx4 v[56:59], v1, s[28:31], s71 offen offset:128 nt
    s_waitcnt vmcnt(5)
    buffer_load_dwordx4 v[60:63], v1, s[28:31], s71 offen offset:256 nt
    s_branch L_x_67
L_y_68:
    s_cmp_eq_u32 s15, 4
    s_cbranch_scc0 L_y_69
    s_waitcnt vmcnt(4)
    buffer_load_dwordx4 v[52:55], v1, s[28:31], s71 offen offset:0 nt
    s_waitcnt vmcnt(4)
    buffer_load_dwordx4 v[56:59], v1, s[28:31], s71 offen offset:128 nt
    s_waitcnt vmcnt(4)
    buffer_load_dwordx4 v[60:63], v1, s[28:31], s71 offen offset:256 nt
    s_branch L_x_67
L_y_69:
    s_cmp_eq_u32 s15, 3
    s_cbranch_scc0 L_y_70
    s_waitcnt vmcnt(3)
    buffer_load_dwordx4 v[52:55], v1, s[28:31], s71 offen offset:0 nt
    s_waitcnt vmcnt(3)
    buffer_load_dwordx4 v[56:59], v1, s[28:31], s71 offen offset:128 nt
    s_waitcnt vmcnt(3)
    buffer_load_dwordx4 v[60:63], v1, s[28:31], s71 offen offset:256 nt
    s_branch L_x_67
L_y_70:
    s_waitcnt vmcnt(6)
L_w_64:
    buffer_load_dwordx4 v[52:55], v1, s[28:31], s71 offen offset:0 nt
    buffer_load_dwordx4 v[56:59], v1, s[28:31], s71 offen offset:128 nt
    buffer_load_dwordx4 v[60:63], v1, s[28:31], s71 offen offset:256 nt
L_x_67:
    s_add_u32 s21, s21, 1
    s_and_b32 s21, s21, 63
    v_readlane_b32 s71, v12, s21
    s_waitcnt vmcnt(21)
L_c_65:
    ds_read_b32 v15, v13 offset:8576
    s_add_u32 s14, s14, 1
    v_dot2c_f32_bf16 v28, v64, v6
    v_dot2c_f32_bf16 v29, v64, v7
    v_dot2c_f32_bf16 v30, v65, v6
    v_dot2c_f32_bf16 v31, v65, v7
    v_dot2c_f32_bf16 v32, v66, v6
    v_dot2c_f32_bf16 v33, v66, v7
    v_dot2c_f32_bf16 v34, v67, v6
    v_dot2c_f32_bf16 v35, v67, v7
    v_dot2c_f32_bf16 v36, v68, v6
    v_dot2c_f32_bf16 v37, v68, v7
    v_dot2c_f32_bf16 v38, v69, v6
    v_dot2c_f32_bf16 v39, v69, v7
    v_dot2c_f32_bf16 v40, v70, v6
    v_dot2c_f32_bf16 v41, v70, v7
    v_dot2c_f32_bf16 v42, v71, v6
    v_dot2c_f32_bf16 v43, v71, v7
    v_dot2c_f32_bf16 v44, v72, v6
    v_dot2c_f32_bf16 v45, v72, v7
    v_dot2c_f32_bf16 v46, v73, v6
    v_dot2c_f32_bf16 v47, v73, v7
    v_dot2c_f32_bf16 v48, v74, v6
    v_dot2c_f32_bf16 v49, v74, v7
    v_dot2c_f32_bf16 v50, v75, v6
    v_dot2c_f32_bf16 v51, v75, v7
    v_sub_f32 v5, v18, v8
    v_sub_f32 v5, v5, v9
    v_exp_f32 v5, v5
    s_nop 0
    v_cvt_pk_bf16_f32 v6, v5, 0
    v_cvt_pk_bf16_f32 v7, 0, v5
    s_cmp_ge_u32 s14, 60
    s_cbranch_scc0 L_n_73
    s_waitcnt vmcnt(15)
    s_branch L_c_72
L_n_73:
    s_waitcnt lgkmcnt(0)
    v_readfirstlane_b32 s20, v15
    v_mov_b32 v2, s14
    s_sub_i32 s72, s14, s20
    s_max_i32 s72, s72, 0
    s_min_i32 s72, s72, 6
    s_lshl_b32 s68, s72, 2
    s_mov_b32 s15, 0x3445599
    s_cmp_ge_u32 s14, 50
    s_cselect_b32 s15, 0x3344599, s15
    s_lshr_b32 s15, s15, s68
    s_and_b32 s15, s15, 15
    s_cmp_eq_u32 s20, 0
    s_cselect_b32 s15, s18, s15
    s_cmp_eq_u32 s15, 5
    s_cbranch_scc0 L_y_75
    s_waitcnt vmcnt(5)
    buffer_load_dwordx4 v[64:67], v1, s[28:31], s71 offen offset:0 nt
    s_waitcnt vmcnt(5)
    buffer_load_dwordx4 v[68:71], v1, s[28:31], s71 offen offset:128 nt
    s_waitcnt vmcnt(5)
    buffer_load_dwordx4 v[72:75], v1, s[28:31], s71 offen offset:256 nt
    s_branch L_x_74
L_y_75:
    s_cmp_eq_u32 s15, 4
    s_cbranch_scc0 L_y_76
    s_waitcnt vmcnt(4)
    buffer_load_dwordx4 v[64:67], v1, s[28:31], s71 offen offset:0 nt
    s_waitcnt vmcnt(4)
    buffer_load_dwordx4 v[68:71], v1, s[28:31], s71 offen offset:128 nt
    s_waitcnt vmcnt(4)
    buffer_load_dwordx4 v[72:75], v1, s[28:31], s71 offen offset:256 nt
    s_branch L_x_74
L_y_76:
    s_cmp_eq_u32 s15, 3
    s_cbranch_scc0 L_y_77
    s_waitcnt vmcnt(3)
    buffer_load_dwordx4 v[64:67], v1, s[28:31], s71 offen offset:0 nt
    s_waitcnt vmcnt(3)
    buffer_load_dwordx4 v[68:71], v1, s[28:31], s71 offen offset:128 nt
    s_waitcnt vmcnt(3)
    buffer_load_dwordx4 v[72:75], v1, s[28:31], s71 offen offset:256 nt
    s_branch L_x_74
L_y_77:
    s_waitcnt vmcnt(6)
L_w_71:
    buffer_load_dwordx4 v[64:67], v1, s[28:31], s71 offen offset:0 nt
    buffer_load_dwordx4 v[68:71], v1, s[28:31], s71 offen offset:128 nt
    buffer_load_dwordx4 v[72:75], v1, s[28:31], s71 offen offset:256 nt
L_x_74:
    s_add_u32 s21, s21, 1
    s_and_b32 s21, s21, 63
    v_readlane_b32 s71, v12, s21
    ds_write_b32 v13, v2 offset:8592
    s_waitcnt vmcnt(21)
L_c_72:
    v_dot2c_f32_bf16 v28, v76, v6
    v_dot2c_f32_bf16 v29, v76, v7
    v_dot2c_f32_bf16 v30, v77, v6
    v_dot2c_f32_bf16 v31, v77, v7
    v_dot2c_f32_bf16 v32, v78, v6
    v_dot2c_f32_bf16 v33, v78, v7
    v_dot2c_f32_bf16 v34, v79, v6
    v_dot2c_f32_bf16 v35, v79, v7
    v_dot2c_f32_bf16 v36, v80, v6
    v_dot2c_f32_bf16 v37, v80, v7
    v_dot2c_f32_bf16 v38, v81, v6
    v_dot2c_f32_bf16 v39, v81, v7
    v_dot2c_f32_bf16 v40, v82, v6
    v_dot2c_f32_bf16 v41, v82, v7
    v_dot2c_f32_bf16 v42, v83, v6
    v_dot2c_f32_bf16 v43, v83, v7
    v_dot2c_f32_bf16 v44, v84, v6
    v_dot2c_f32_bf16 v45, v84, v7
    v_dot2c_f32_bf16 v46, v85, v6
    v_dot2c_f32_bf16 v47, v85, v7
    v_dot2c_f32_bf16 v48, v86, v6
    v_dot2c_f32_bf16 v49, v86, v7
    v_dot2c_f32_bf16 v50, v87, v6
    v_dot2c_f32_bf16 v51, v87, v7
    v_sub_f32 v5, v19, v8
    v_sub_f32 v5, v5, v9
    v_exp_f32 v5, v5
    s_nop 0
    v_cvt_pk_bf16_f32 v6, v5, 0
    v_cvt_pk_bf16_f32 v7, 0, v5
    s_cmp_ge_u32 s14, 60
    s_cbranch_scc0 L_n_80
    s_waitcnt vmcnt(12)
    s_branch L_c_79
L_n_80:
    s_cmp_eq_u32 s15, 5
    s_cbranch_scc0 L_y_82
    s_waitcnt vmcnt(5)
    buffer_load_dwordx4 v[76:79], v1, s[28:31], s71 offen offset:0 nt
    s_waitcnt vmcnt(5)
    buffer_load_dwordx4 v[80:83], v1, s[28:31], s71 offen offset:128 nt
    s_waitcnt vmcnt(5)
    buffer_load_dwordx4 v[84:87], v1, s[28:31], s71 offen offset:256 nt
    s_branch L_x_81
L_y_82:
    s_cmp_eq_u32 s15, 4
    s_cbranch_scc0 L_y_83
    s_waitcnt vmcnt(4)
    buffer_load_dwordx4 v[76:79], v1, s[28:31], s71 offen offset:0 nt
    s_waitcnt vmcnt(4)
    buffer_load_dwordx4 v[80:83], v1, s[28:31], s71 offen offset:128 nt
    s_waitcnt vmcnt(4)
    buffer_load_dwordx4 v[84:87], v1, s[28:31], s71 offen offset:256 nt
    s_branch L_x_81
L_y_83:
    s_cmp_eq_u32 s15, 3
    s_cbranch_scc0 L_y_84
    s_waitcnt vmcnt(3)
    buffer_load_dwordx4 v[76:79], v1, s[28:31], s71 offen offset:0 nt
    s_waitcnt vmcnt(3)
    buffer_load_dwordx4 v[80:83], v1, s[28:31], s71 offen offset:128 nt
    s_waitcnt vmcnt(3)
    buffer_load_dwordx4 v[84:87], v1, s[28:31], s71 offen offset:256 nt
    s_branch L_x_81
L_y_84:
    s_waitcnt vmcnt(6)
L_w_78:
    buffer_load_dwordx4 v[76:79], v1, s[28:31], s71 offen offset:0 nt
    buffer_load_dwordx4 v[80:83], v1, s[28:31], s71 offen offset:128 nt
    buffer_load_dwordx4 v[84:87], v1, s[28:31], s71 offen offset:256 nt
L_x_81:
    s_add_u32 s21, s21, 1
    s_and_b32 s21, s21, 63
    v_readlane_b32 s71, v12, s21
    s_waitcnt vmcnt(21)
L_c_79:
    ds_read_b32 v15, v13 offset:8576
    s_add_u32 s14, s14, 1
    v_dot2c_f32_bf16 v28, v88, v6
    v_dot2c_f32_bf16 v29, v88, v7
    v_dot2c_f32_bf16 v30, v89, v6
    v_dot2c_f32_bf16 v31, v89, v7
    v_dot2c_f32_bf16 v32, v90, v6
    v_dot2c_f32_bf16 v33, v90, v7
    v_dot2c_f32_bf16 v34, v91, v6
    v_dot2c_f32_bf16 v35, v91, v7
    v_dot2c_f32_bf16 v36, v92, v6
    v_dot2c_f32_bf16 v37, v92, v7
    v_dot2c_f32_bf16 v38, v93, v6
    v_dot2c_f32_bf16 v39, v93, v7
    v_dot2c_f32_bf16 v40, v94, v6
    v_dot2c_f32_bf16 v41, v94, v7
    v_dot2c_f32_bf16 v42, v95, v6
    v_dot2c_f32_bf16 v43, v95, v7
    v_dot2c_f32_bf16 v44, v96, v6
    v_dot2c_f32_bf16 v45, v96, v7
    v_dot2c_f32_bf16 v46, v97, v6
    v_dot2c_f32_bf16 v47, v97, v7
    v_dot2c_f32_bf16 v48, v98, v6
    v_dot2c_f32_bf16 v49, v98, v7
    v_dot2c_f32_bf16 v50, v99, v6
    v_dot2c_f32_bf16 v51, v99, v7
    v_sub_f32 v5, v20, v8
    v_sub_f32 v5, v5, v9
    v_exp_f32 v5, v5
    s_nop 0
    v_cvt_pk_bf16_f32 v6, v5, 0
    v_cvt_pk_bf16_f32 v7, 0, v5
    s_cmp_ge_u32 s14, 60
    s_cbranch_scc0 L_n_87
    s_waitcnt vmcnt(9)
    s_branch L_c_86
L_n_87:
    s_waitcnt lgkmcnt(0)
    v_readfirstlane_b32 s20, v15
    v_mov_b32 v2, s14
    s_sub_i32 s72, s14, s20
    s_max_i32 s72, s72, 0
    s_min_i32 s72, s72, 6
    s_lshl_b32 s68, s72, 2
    s_mov_b32 s15, 0x3445599
    s_cmp_ge_u32 s14, 50
    s_cselect_b32 s15, 0x3344599, s15
    s_lshr_b32 s15, s15, s68
    s_and_b32 s15, s15, 15
    s_cmp_eq_u32 s20, 0
    s_cselect_b32 s15, s18, s15
    s_cmp_eq_u32 s15, 5
    s_cbranch_scc0 L_y_89
    s_waitcnt vmcnt(5)
    buffer_load_dwordx4 v[88:91], v1, s[28:31], s71 offen offset:0 nt
    s_waitcnt vmcnt(5)
    buffer_load_dwordx4 v[92:95], v1, s[28:31], s71 offen offset:128 nt
    s_waitcnt vmcnt(5)
    buffer_load_dwordx4 v[96:99], v1, s[28:31], s71 offen offset:256 nt
    s_branch L_x_88
L_y_89:
    s_cmp_eq_u32 s15, 4
    s_cbranch_scc0 L_y_90
    s_waitcnt vmcnt(4)
    buffer_load_dwordx4 v[88:91], v1, s[28:31], s71 offen offset:0 nt
    s_waitcnt vmcnt(4)
    buffer_load_dwordx4 v[92:95], v1, s[28:31], s71 offen offset:128 nt
    s_waitcnt vmcnt(4)
    buffer_load_dwordx4 v[96:99], v1, s[28:31], s71 offen offset:256 nt
    s_branch L_x_88
L_y_90:
    s_cmp_eq_u32 s15, 3
    s_cbranch_scc0 L_y_91
    s_waitcnt vmcnt(3)
    buffer_load_dwordx4 v[88:91], v1, s[28:31], s71 offen offset:0 nt
    s_waitcnt vmcnt(3)
    buffer_load_dwordx4 v[92:95], v1, s[28:31], s71 offen offset:128 nt
    s_waitcnt vmcnt(3)
    buffer_load_dwordx4 v[96:99], v1, s[28:31], s71 offen offset:256 nt
    s_branch L_x_88
L_y_91:
    s_waitcnt vmcnt(6)
L_w_85:
    buffer_load_dwordx4 v[88:91], v1, s[28:31], s71 offen offset:0 nt
    buffer_load_dwordx4 v[92:95], v1, s[28:31], s71 offen offset:128 nt
    buffer_load_dwordx4 v[96:99], v1, s[28:31], s71 offen offset:256 nt
L_x_88:
    s_add_u32 s21, s21, 1
    s_and_b32 s21, s21, 63
    v_readlane_b32 s71, v12, s21
    ds_write_b32 v13, v2 offset:8592
    s_waitcnt vmcnt(21)
L_c_86:
    v_dot2c_f32_bf16 v28, v100, v6
    v_dot2c_f32_bf16 v29, v100, v7
    v_dot2c_f32_bf16 v30, v101, v6
    v_dot2c_f32_bf16 v31, v101, v7
    v_dot2c_f32_bf16 v32, v102, v6
    v_dot2c_f32_bf16 v33, v102, v7
    v_dot2c_f32_bf16 v34, v103, v6
    v_dot2c_f32_bf16 v35, v103, v7
    v_dot2c_f32_bf16 v36, v104, v6
    v_dot2c_f32_bf16 v37, v104, v7
    v_dot2c_f32_bf16 v38, v105, v6
    v_dot2c_f32_bf16 v39, v105, v7
    v_dot2c_f32_bf16 v40, v106, v6
    v_dot2c_f32_bf16 v41, v106, v7
    v_dot2c_f32_bf16 v42, v107, v6
    v_dot2c_f32_bf16 v43, v107, v7
    v_dot2c_f32_bf16 v44, v108, v6
    v_dot2c_f32_bf16 v45, v108, v7
    v_dot2c_f32_bf16 v46, v109, v6
    v_dot2c_f32_bf16 v47, v109, v7
    v_dot2c_f32_bf16 v48, v110, v6
    v_dot2c_f32_bf16 v49, v110, v7
    v_dot2c_f32_bf16 v50, v111, v6
    v_dot2c_f32_bf16 v51, v111, v7
    v_sub_f32 v5, v21, v8
    v_sub_f32 v5, v5, v9
    v_exp_f32 v5, v5
    s_nop 0
    v_cvt_pk_bf16_f32 v6, v5, 0
    v_cvt_pk_bf16_f32 v7, 0, v5
    s_cmp_ge_u32 s14, 60
    s_cbranch_scc0 L_n_94
    s_waitcnt vmcnt(6)
    s_branch L_c_93
L_n_94:
    s_cmp_eq_u32 s15, 5
    s_cbranch_scc0 L_y_96
    s_waitcnt vmcnt(5)
    buffer_load_dwordx4 v[100:103], v1, s[28:31], s71 offen offset:0 nt
    s_waitcnt vmcnt(5)
    buffer_load_dwordx4 v[104:107], v1, s[28:31], s71 offen offset:128 nt
    s_waitcnt vmcnt(5)
    buffer_load_dwordx4 v[108:111], v1, s[28:31], s71 offen offset:256 nt
    s_branch L_x_95
L_y_96:
    s_cmp_eq_u32 s15, 4
    s_cbranch_scc0 L_y_97
    s_waitcnt vmcnt(4)
    buffer_load_dwordx4 v[100:103], v1, s[28:31], s71 offen offset:0 nt
    s_waitcnt vmcnt(4)
    buffer_load_dwordx4 v[104:107], v1, s[28:31], s71 offen offset:128 nt
    s_waitcnt vmcnt(4)
    buffer_load_dwordx4 v[108:111], v1, s[28:31], s71 offen offset:256 nt
    s_branch L_x_95
L_y_97:
    s_cmp_eq_u32 s15, 3
    s_cbranch_scc0 L_y_98
    s_waitcnt vmcnt(3)
    buffer_load_dwordx4 v[100:103], v1, s[28:31], s71 offen offset:0 nt
    s_waitcnt vmcnt(3)
    buffer_load_dwordx4 v[104:107], v1, s[28:31], s71 offen offset:128 nt
    s_waitcnt vmcnt(3)
    buffer_load_dwordx4 v[108:111], v1, s[28:31], s71 offen offset:256 nt
    s_branch L_x_95
L_y_98:
    s_waitcnt vmcnt(6)
L_w_92:
    buffer_load_dwordx4 v[100:103], v1, s[28:31], s71 offen offset:0 nt
    buffer_load_dwordx4 v[104:107], v1, s[28:31], s71 offen offset:128 nt
    buffer_load_dwordx4 v[108:111], v1, s[28:31], s71 offen offset:256 nt
L_x_95:
    s_add_u32 s21, s21, 1
    s_and_b32 s21, s21, 63
    v_readlane_b32 s71, v12, s21
    s_waitcnt vmcnt(21)
L_c_93:
    ds_read_b32 v15, v13 offset:8576
    s_add_u32 s14, s14, 1
    v_dot2c_f32_bf16 v28, v112, v6
    v_dot2c_f32_bf16 v29, v112, v7
    v_dot2c_f32_bf16 v30, v113, v6
    v_dot2c_f32_bf16 v31, v113, v7
    v_dot2c_f32_bf16 v32, v114, v6
    v_dot2c_f32_bf16 v33, v114, v7
    v_dot2c_f32_bf16 v34, v115, v6
    v_dot2c_f32_bf16 v35, v115, v7
    v_dot2c_f32_bf16 v36, v116, v6
    v_dot2c_f32_bf16 v37, v116, v7
    v_dot2c_f32_bf16 v38, v117, v6
    v_dot2c_f32_bf16 v39, v117, v7
    v_dot2c_f32_bf16 v40, v118, v6
    v_dot2c_f32_bf16 v41, v118, v7
    v_dot2c_f32_bf16 v42, v119, v6
    v_dot2c_f32_bf16 v43, v119, v7
    v_dot2c_f32_bf16 v44, v120, v6
    v_dot2c_f32_bf16 v45, v120, v7
    v_dot2c_f32_bf16 v46, v121, v6
    v_dot2c_f32_bf16 v47, v121, v7
    v_dot2c_f32_bf16 v48, v122, v6
    v_dot2c_f32_bf16 v49, v122, v7
    v_dot2c_f32_bf16 v50, v123, v6
    v_dot2c_f32_bf16 v51, v123, v7
    v_sub_f32 v5, v22, v8
    v_sub_f32 v5, v5, v9
    v_exp_f32 v5, v5
    s_nop 0
    v_cvt_pk_bf16_f32 v6, v5, 0
    v_cvt_pk_bf16_f32 v7, 0, v5
    s_cmp_ge_u32 s14, 60
    s_cbranch_scc0 L_n_101
    s_waitcnt vmcnt(3)
    s_add_u32 m0, s17, 0
    s_add_u32 s68, s16, 0
    buffer_load_dwordx4 v200, s[48:51], s68 offen nt lds
    s_add_u32 m0, s17, 1024
    s_add_u32 s68, s16, 10240
    buffer_load_dwordx4 v200, s[48:51], s68 offen nt lds
    s_add_u32 m0, s17, 2048
    s_add_u32 s68, s16, 20480
    buffer_load_dwordx4 v200, s[48:51], s68 offen nt lds
    s_add_u32 m0, s17, 3072
    s_add_u32 s68, s16, 30720
    buffer_load_dwordx4 v200, s[48:51], s68 offen nt lds
    s_add_u32 m0, s17, 4096
    s_add_u32 s68, s16, 40960
    buffer_load_dwordx4 v200, s[48:51], s68 offen nt lds
    s_add_u32 m0, s17, 5120
    s_add_u32 s68, s16, 51200
    buffer_load_dwordx4 v200, s[48:51], s68 offen nt lds
    s_branch L_c_100
L_n_101:
    s_waitcnt lgkmcnt(0)
    v_readfirstlane_b32 s20, v15
    v_mov_b32 v2, s14
    s_sub_i32 s72, s14, s20
    s_max_i32 s72, s72, 0
    s_min_i32 s72, s72, 6
    s_lshl_b32 s68, s72, 2
    s_mov_b32 s15, 0x3445599
    s_cmp_ge_u32 s14, 50
    s_cselect_b32 s15, 0x3344599, s15
    s_lshr_b32 s15, s15, s68
    s_and_b32 s15, s15, 15
    s_cmp_eq_u32 s20, 0
    s_cselect_b32 s15, s18, s15
    s_cmp_eq_u32 s15, 5
    s_cbranch_scc0 L_y_103
    s_waitcnt vmcnt(5)
    buffer_load_dwordx4 v[112:115], v1, s[28:31], s71 offen offset:0 nt
    s_waitcnt vmcnt(5)
    buffer_load_dwordx4 v[116:119], v1, s[28:31], s71 offen offset:128 nt
    s_waitcnt vmcnt(5)
    buffer_load_dwordx4 v[120:123], v1, s[28:31], s71 offen offset:256 nt
    s_branch L_x_102
L_y_103:
    s_cmp_eq_u32 s15, 4
    s_cbranch_scc0 L_y_104
    s_waitcnt vmcnt(4)
    buffer_load_dwordx4 v[112:115], v1, s[28:31], s71 offen offset:0 nt
    s_waitcnt vmcnt(4)
    buffer_load_dwordx4 v[116:119], v1, s[28:31], s71 offen offset:128 nt
    s_waitcnt vmcnt(4)
    buffer_load_dwordx4 v[120:123], v1, s[28:31], s71 offen offset:256 nt
    s_branch L_x_102
L_y_104:
    s_cmp_eq_u32 s15, 3
    s_cbranch_scc0 L_y_105
    s_waitcnt vmcnt(3)
    buffer_load_dwordx4 v[112:115], v1, s[28:31], s71 offen offset:0 nt
    s_waitcnt vmcnt(3)
    buffer_load_dwordx4 v[116:119], v1, s[28:31], s71 offen offset:128 nt
    s_waitcnt vmcnt(3)
    buffer_load_dwordx4 v[120:123], v1, s[28:31], s71 offen offset:256 nt
    s_branch L_x_102
L_y_105:
    s_waitcnt vmcnt(6)
L_w_99:
    buffer_load_dwordx4 v[112:115], v1, s[28:31], s71 offen offset:0 nt
    buffer_load_dwordx4 v[116:119], v1, s[28:31], s71 offen offset:128 nt
    buffer_load_dwordx4 v[120:123], v1, s[28:31], s71 offen offset:256 nt
L_x_102:
    s_add_u32 s21, s21, 1
    s_and_b32 s21, s21, 63
    v_readlane_b32 s71, v12, s21
    ds_write_b32 v13, v2 offset:8592
    s_waitcnt vmcnt(21)
L_c_100:
    v_dot2c_f32_bf16 v28, v124, v6
    v_dot2c_f32_bf16 v29, v124, v7
    v_dot2c_f32_bf16 v30, v125, v6
    v_dot2c_f32_bf16 v31, v125, v7
    v_dot2c_f32_bf16 v32, v126, v6
    v_dot2c_f32_bf16 v33, v126, v7
    v_dot2c_f32_bf16 v34, v127, v6
    v_dot2c_f32_bf16 v35, v127, v7
    v_dot2c_f32_bf16 v36, v128, v6
    v_dot2c_f32_bf16 v37, v128, v7
    v_dot2c_f32_bf16 v38, v129, v6
    v_dot2c_f32_bf16 v39, v129, v7
    v_dot2c_f32_bf16 v40, v130, v6
    v_dot2c_f32_bf16 v41, v130, v7
    v_dot2c_f32_bf16 v42, v131, v6
    v_dot2c_f32_bf16 v43, v131, v7
    v_dot2c_f32_bf16 v44, v132, v6
    v_dot2c_f32_bf16 v45, v132, v7
    v_dot2c_f32_bf16 v46, v133, v6
    v_dot2c_f32_bf16 v47, v133, v7
    v_dot2c_f32_bf16 v48, v134, v6
    v_dot2c_f32_bf16 v49, v134, v7
    v_dot2c_f32_bf16 v50, v135, v6
    v_dot2c_f32_bf16 v51, v135, v7
    v_sub_f32 v5, v23, v8
    v_sub_f32 v5, v5, v9
    v_exp_f32 v5, v5
    s_nop 0
    v_cvt_pk_bf16_f32 v6, v5, 0
    v_cvt_pk_bf16_f32 v7, 0, v5
    s_cmp_ge_u32 s14, 60
    s_cbranch_scc0 L_n_108
    s_waitcnt vmcnt(6)
    s_branch L_c_107
L_n_108:
    s_cmp_eq_u32 s15, 5
    s_cbranch_scc0 L_y_110
    s_waitcnt vmcnt(5)
    buffer_load_dwordx4 v[124:127], v1, s[28:31], s71 offen offset:0 nt
    s_waitcnt vmcnt(5)
    buffer_load_dwordx4 v[128:131], v1, s[28:31], s71 offen offset:128 nt
    s_waitcnt vmcnt(5)
    buffer_load_dwordx4 v[132:135], v1, s[28:31], s71 offen offset:256 nt
    s_branch L_x_109
L_y_110:
    s_cmp_eq_u32 s15, 4
    s_cbranch_scc0 L_y_111
    s_waitcnt vmcnt(4)
    buffer_load_dwordx4 v[124:127], v1, s[28:31], s71 offen offset:0 nt
    s_waitcnt vmcnt(4)
    buffer_load_dwordx4 v[128:131], v1, s[28:31], s71 offen offset:128 nt
    s_waitcnt vmcnt(4)
    buffer_load_dwordx4 v[132:135], v1, s[28:31], s71 offen offset:256 nt
    s_branch L_x_109
L_y_111:
    s_cmp_eq_u32 s15, 3
    s_cbranch_scc0 L_y_112
    s_waitcnt vmcnt(3)
    buffer_load_dwordx4 v[124:127], v1, s[28:31], s71 offen offset:0 nt
    s_waitcnt vmcnt(3)
    buffer_load_dwordx4 v[128:131], v1, s[28:31], s71 offen offset:128 nt
    s_waitcnt vmcnt(3)
    buffer_load_dwordx4 v[132:135], v1, s[28:31], s71 offen offset:256 nt
    s_branch L_x_109
L_y_112:
    s_waitcnt vmcnt(6)
L_w_106:
    buffer_load_dwordx4 v[124:127], v1, s[28:31], s71 offen offset:0 nt
    buffer_load_dwordx4 v[128:131], v1, s[28:31], s71 offen offset:128 nt
    buffer_load_dwordx4 v[132:135], v1, s[28:31], s71 offen offset:256 nt
L_x_109:
    s_add_u32 s21, s21, 1
    s_and_b32 s21, s21, 63
    v_readlane_b32 s71, v12, s21
    s_waitcnt vmcnt(21)
L_c_107:
    ds_read_b32 v15, v13 offset:8576
    s_add_u32 s14, s14, 1
    v_dot2c_f32_bf16 v28, v136, v6
    v_dot2c_f32_bf16 v29, v136, v7
    v_dot2c_f32_bf16 v30, v137, v6
    v_dot2c_f32_bf16 v31, v137, v7
    v_dot2c_f32_bf16 v32, v138, v6
    v_dot2c_f32_bf16 v33, v138, v7
    v_dot2c_f32_bf16 v34, v139, v6
    v_dot2c_f32_bf16 v35, v139, v7
    v_dot2c_f32_bf16 v36, v140, v6
    v_dot2c_f32_bf16 v37, v140, v7
    v_dot2c_f32_bf16 v38, v141, v6
    v_dot2c_f32_bf16 v39, v141, v7
    v_dot2c_f32_bf16 v40, v142, v6
    v_dot2c_f32_bf16 v41, v142, v7
    v_dot2c_f32_bf16 v42, v143, v6
    v_dot2c_f32_bf16 v43, v143, v7
    v_dot2c_f32_bf16 v44, v144, v6
    v_dot2c_f32_bf16 v45, v144, v7
    v_dot2c_f32_bf16 v46, v145, v6
    v_dot2c_f32_bf16 v47, v145, v7
    v_dot2c_f32_bf16 v48, v146, v6
    v_dot2c_f32_bf16 v49, v146, v7
    v_dot2c_f32_bf16 v50, v147, v6
    v_dot2c_f32_bf16 v51, v147, v7
    s_bitcmp1_b32 s14, 2
    s_cbranch_scc1 L_vloop
    s_cmp_ge_u32 s14, 64
    v_permlane32_swap_b32 v28, v32
    v_permlane32_swap_b32 v29, v33
    v_permlane32_swap_b32 v30, v34
    v_permlane32_swap_b32 v31, v35
    v_permlane32_swap_b32 v36, v40
    v_permlane32_swap_b32 v37, v41
    v_permlane32_swap_b32 v38, v42
    v_permlane32_swap_b32 v39, v43
    v_permlane32_swap_b32 v44, v48
    v_permlane32_swap_b32 v45, v49
    v_permlane32_swap_b32 v46, v50
    v_permlane32_swap_b32 v47, v51
    v_pk_add_f32 v[28:29], v[28:29], v[32:33]
    v_pk_add_f32 v[30:31], v[30:31], v[34:35]
    v_pk_add_f32 v[36:37], v[36:37], v[40:41]
    v_pk_add_f32 v[38:39], v[38:39], v[42:43]
    v_pk_add_f32 v[44:45], v[44:45], v[48:49]
    v_pk_add_f32 v[46:47], v[46:47], v[50:51]
    v_permlane16_swap_b32 v28, v30
    v_permlane16_swap_b32 v29, v31
    v_permlane16_swap_b32 v36, v38
    v_permlane16_swap_b32 v37, v39
    v_permlane16_swap_b32 v44, v46
    v_permlane16_swap_b32 v45, v47
    v_pk_add_f32 v[28:29], v[28:29], v[30:31]
    v_pk_add_f32 v[36:37], v[36:37], v[38:39]
    v_pk_add_f32 v[44:45], v[44:45], v[46:47]
    v_add_f32_dpp v28, v28, v28 row_ror:8 row_mask:0xf bank_mask:0xf
    v_add_f32_dpp v29, v29, v29 row_ror:8 row_mask:0xf bank_mask:0xf
    ds_write_b64 v14, v[28:29] offset:16896
    v_add_f32_dpp v36, v36, v36 row_ror:8 row_mask:0xf bank_mask:0xf
    v_add_f32_dpp v37, v37, v37 row_ror:8 row_mask:0xf bank_mask:0xf
    ds_write_b64 v14, v[36:37] offset:17152
    v_add_f32_dpp v44, v44, v44 row_ror:8 row_mask:0xf bank_mask:0xf
    v_add_f32_dpp v45, v45, v45 row_ror:8 row_mask:0xf bank_mask:0xf
    ds_write_b64 v14, v[44:45] offset:17408
    s_waitcnt lgkmcnt(0)
    s_cbranch_scc1 L_vdone
    v_mov_b32 v28, 0
    v_mov_b32 v29, 0
    v_mov_b32 v30, 0
    v_mov_b32 v31, 0
    v_mov_b32 v32, 0
    v_mov_b32 v33, 0
    v_mov_b32 v34, 0
    v_mov_b32 v35, 0
    v_mov_b32 v36, 0
    v_mov_b32 v37, 0
    v_mov_b32 v38, 0
    v_mov_b32 v39, 0
    v_mov_b32 v40, 0
    v_mov_b32 v41, 0
    v_mov_b32 v42, 0
    v_mov_b32 v43, 0
    v_mov_b32 v44, 0
    v_mov_b32 v45, 0
    v_mov_b32 v46, 0
    v_mov_b32 v47, 0
    v_mov_b32 v48, 0
    v_mov_b32 v49, 0
    v_mov_b32 v50, 0
    v_mov_b32 v51, 0
    v_add_u32 v14, 3072, v14
    s_branch L_vbatch
L_vdone:
    s_barrier
    v_lshrrev_b32 v1, 4, v0
    v_and_b32 v3, 3, v0
    v_lshrrev_b32 v2, 2, v0
    v_bfe_u32 v4, v0, 3, 2
    v_xor_b32 v4, s3, v4
    v_lshl_add_u32 v4, v2, 2, v4
    v_lshl_add_u32 v5, v4, 2, v3
    v_lshlrev_b32 v5, 3, v5
    v_add_u32 v5, 57856, v5
    v_lshlrev_b32 v4, 3, v0
    v_add_u32 v4, 82432, v4
    s_cmp_eq_u32 s3, 4
    s_waitcnt vmcnt(0)
    s_barrier
    s_cbranch_scc1 L_b4
    ds_read_b64_tr_b16 v[52:53], v5 offset:0
    ds_read_b64_tr_b16 v[54:55], v5 offset:2048
    ds_read_b64_tr_b16 v[56:57], v5 offset:4096
    ds_read_b64_tr_b16 v[58:59], v5 offset:6144
    ds_read_b64_tr_b16 v[60:61], v5 offset:8192
    ds_read_b64_tr_b16 v[62:63], v5 offset:10240
    ds_read_b64_tr_b16 v[64:65], v5 offset:12288
    ds_read_b64_tr_b16 v[66:67], v5 offset:14336
    ds_read_b64_tr_b16 v[68:69], v5 offset:16384
    ds_read_b64_tr_b16 v[70:71], v5 offset:18432
    ds_read_b64_tr_b16 v[72:73], v5 offset:20480
    ds_read_b64_tr_b16 v[74:75], v5 offset:22528
    s_lshl2_add_u32 s71, s60, s3
    s_branch L_b5
L_b4:
    ds_read_b64_tr_b16 v[52:53], v4 offset:0
    ds_read_b64_tr_b16 v[54:55], v4 offset:512
    ds_read_b64_tr_b16 v[56:57], v4 offset:1024
    ds_read_b64_tr_b16 v[58:59], v4 offset:1536
    ds_read_b64_tr_b16 v[60:61], v4 offset:2048
    ds_read_b64_tr_b16 v[62:63], v4 offset:2560
    ds_read_b64_tr_b16 v[64:65], v4 offset:3072
    ds_read_b64_tr_b16 v[66:67], v4 offset:3584
    ds_read_b64_tr_b16 v[68:69], v4 offset:4096
    ds_read_b64_tr_b16 v[70:71], v4 offset:4608
    ds_read_b64_tr_b16 v[72:73], v4 offset:5120
    ds_read_b64_tr_b16 v[74:75], v4 offset:5632
    s_add_u32 s71, s60, 32
L_b5:
    s_mul_i32 s67, s27, 40
    s_add_u32 s71, s71, s67
    v_and_b32 v2, 15, v0
    v_mul_u32_u24 v4, 528, v2
    v_lshl_add_u32 v4, v1, 4, v4
    v_lshlrev_b32 v6, 2, v0
    s_movk_i32 s68, 15
    s_mov_b32 s78, 0
    s_mov_b32 s79, 0xffff0000
    s_lshl_b32 s71, s71, 8
    s_add_u32 s71, s71, 851968
    v_mov_b32 v13, 0
    ds_read_b32 v13, v13 offset:8672
    s_waitcnt lgkmcnt(0)
    s_barrier
    ds_read_b128 v[16:19], v4 offset:29184
    ds_read_b128 v[20:23], v4 offset:29248
    ds_read_b128 v[24:27], v4 offset:29312
    ds_read_b128 v[28:31], v4 offset:29376
    ds_read_b128 v[32:35], v4 offset:29440
    ds_read_b128 v[36:39], v4 offset:29504
    s_waitcnt lgkmcnt(5)
    v_mfma_f32_16x16x32_bf16 v[8:11], v[16:19], v[52:55], 0
    s_waitcnt lgkmcnt(4)
    v_mfma_f32_16x16x32_bf16 v[8:11], v[20:23], v[56:59], v[8:11]
    s_waitcnt lgkmcnt(3)
    v_mfma_f32_16x16x32_bf16 v[8:11], v[24:27], v[60:63], v[8:11]
    s_waitcnt lgkmcnt(2)
    v_mfma_f32_16x16x32_bf16 v[8:11], v[28:31], v[64:67], v[8:11]
    s_waitcnt lgkmcnt(1)
    v_mfma_f32_16x16x32_bf16 v[8:11], v[32:35], v[68:71], v[8:11]
    s_waitcnt lgkmcnt(0)
    v_mfma_f32_16x16x32_bf16 v[8:11], v[36:39], v[72:75], v[8:11]
    s_nop 7
    v_add_f32 v9, v9, v10
    s_nop 1
    v_permlane32_swap_b32 v10, v9
    v_add_f32 v9, v9, v10
    s_nop 1
    v_permlane16_swap_b32 v10, v9
    v_add_f32 v9, v9, v10
    v_cndmask_b32 v12, v8, v9, s[78:79]
    v_bfi_b32 v12, s68, v13, v12
    buffer_store_dword v12, v6, s[40:43], s71 offen sc1
    s_waitcnt vmcnt(0)
    s_barrier
    s_endpgm
L_pacer:
    s_mov_b32 s48, s12
    s_mov_b32 s49, s13
    s_mov_b32 s50, 7864320
    s_mov_b32 s51, 0x20000
    s_mov_b32 s52, s18
    s_mov_b32 s53, s19
    s_mov_b32 s54, 1966080
    s_mov_b32 s55, 0x20000
    s_mul_i32 s71, s27, 245760
    s_lshl_b32 s67, s60, 5
    s_add_u32 s71, s71, s67
    s_add_u32 s71, s71, 1024
    v_lshrrev_b32 v2, 1, v0
    v_mul_u32_u24 v2, 1280, v2
    v_and_b32 v3, 1, v0
    s_mov_b32 m0, 82432
    v_lshl_add_u32 v2, v3, 4, v2
    buffer_load_dwordx4 v2, s[48:51], s71 offen nt lds
    s_add_u32 m0, m0, 1024
    s_add_u32 s71, s71, 40960
    buffer_load_dwordx4 v2, s[48:51], s71 offen nt lds
    s_add_u32 m0, m0, 1024
    s_add_u32 s71, s71, 40960
    buffer_load_dwordx4 v2, s[48:51], s71 offen nt lds
    s_add_u32 m0, m0, 1024
    s_add_u32 s71, s71, 40960
    buffer_load_dwordx4 v2, s[48:51], s71 offen nt lds
    s_add_u32 m0, m0, 1024
    s_add_u32 s71, s71, 40960
    buffer_load_dwordx4 v2, s[48:51], s71 offen nt lds
    s_add_u32 m0, m0, 1024
    s_add_u32 s71, s71, 40960
    buffer_load_dwordx4 v2, s[48:51], s71 offen nt lds
    s_cmp_lt_u32 s60, 6
    s_cbranch_scc1 L_pc_now2
    s_mov_b32 s67, 0xcccd
    v_add_u32 v2, 0, v0
    v_mul_lo_u32 v3, v2, s67
    v_lshrrev_b32 v3, 19, v3
    v_mul_u32_u24 v4, 10, v3
    v_sub_u32 v4, v2, v4
    v_mul_u32_u24 v3, 1280, v3
    v_lshl_add_u32 v60, v4, 4, v3
    v_add_u32 v2, 64, v0
    v_mul_lo_u32 v3, v2, s67
    v_lshrrev_b32 v3, 19, v3
    v_mul_u32_u24 v4, 10, v3
    v_sub_u32 v4, v2, v4
    v_mul_u32_u24 v3, 1280, v3
    v_lshl_add_u32 v61, v4, 4, v3
    v_add_u32 v2, 128, v0
    v_mul_lo_u32 v3, v2, s67
    v_lshrrev_b32 v3, 19, v3
    v_mul_u32_u24 v4, 10, v3
    v_sub_u32 v4, v2, v4
    v_mul_u32_u24 v3, 1280, v3
    v_lshl_add_u32 v62, v4, 4, v3
    v_add_u32 v2, 192, v0
    v_mul_lo_u32 v3, v2, s67
    v_lshrrev_b32 v3, 19, v3
    v_mul_u32_u24 v4, 10, v3
    v_sub_u32 v4, v2, v4
    v_mul_u32_u24 v3, 1280, v3
    v_lshl_add_u32 v63, v4, 4, v3
    v_add_u32 v2, 256, v0
    v_mul_lo_u32 v3, v2, s67
    v_lshrrev_b32 v3, 19, v3
    v_mul_u32_u24 v4, 10, v3
    v_sub_u32 v4, v2, v4
    v_mul_u32_u24 v3, 1280, v3
    v_lshl_add_u32 v64, v4, 4, v3
    s_lshl_b32 s69, s27, 1
    s_add_u32 s69, s69, s60
    s_sub_u32 s69, s69, 6
    s_lshr_b32 s70, s69, 3
    s_and_b32 s69, s69, 7
    s_mul_i32 s71, s70, 245760
    s_mul_i32 s67, s69, 160
    s_add_u32 s71, s71, s67
    s_mov_b32 m0, 88576
    s_nop 0
    buffer_load_dwordx4 v60, s[52:55], s71 offen nt lds
    s_add_u32 m0, m0, 1024
    s_nop 0
    buffer_load_dwordx4 v61, s[52:55], s71 offen nt lds
    s_add_u32 m0, m0, 1024
    s_nop 0
    buffer_load_dwordx4 v62, s[52:55], s71 offen nt lds
    s_add_u32 m0, m0, 1024
    s_nop 0
    buffer_load_dwordx4 v63, s[52:55], s71 offen nt lds
    s_add_u32 m0, m0, 1024
    s_nop 0
    buffer_load_dwordx4 v64, s[52:55], s71 offen nt lds
    s_add_u32 m0, m0, 1024
    s_add_u32 s71, s71, 40960
    s_nop 0
    buffer_load_dwordx4 v60, s[52:55], s71 offen nt lds
    s_add_u32 m0, m0, 1024
    s_nop 0
    buffer_load_dwordx4 v61, s[52:55], s71 offen nt lds
    s_add_u32 m0, m0, 1024
    s_nop 0
    buffer_load_dwordx4 v62, s[52:55], s71 offen nt lds
    s_add_u32 m0, m0, 1024
    s_nop 0
    buffer_load_dwordx4 v63, s[52:55], s71 offen nt lds
    s_add_u32 m0, m0, 1024
    s_nop 0
    buffer_load_dwordx4 v64, s[52:55], s71 offen nt lds
    s_add_u32 m0, m0, 1024
    s_add_u32 s71, s71, 40960
    s_nop 0
    buffer_load_dwordx4 v60, s[52:55], s71 offen nt lds
    s_add_u32 m0, m0, 1024
    s_nop 0
    buffer_load_dwordx4 v61, s[52:55], s71 offen nt lds
    s_add_u32 m0, m0, 1024
    s_nop 0
    buffer_load_dwordx4 v62, s[52:55], s71 offen nt lds
    s_add_u32 m0, m0, 1024
    s_nop 0
    buffer_load_dwordx4 v63, s[52:55], s71 offen nt lds
    s_add_u32 m0, m0, 1024
    s_nop 0
    buffer_load_dwordx4 v64, s[52:55], s71 offen nt lds
    s_add_u32 m0, m0, 1024
    s_add_u32 s71, s71, 40960
    s_nop 0
    buffer_load_dwordx4 v60, s[52:55], s71 offen nt lds
    s_add_u32 m0, m0, 1024
    s_nop 0
    buffer_load_dwordx4 v61, s[52:55], s71 offen nt lds
    s_add_u32 m0, m0, 1024
    s_nop 0
    buffer_load_dwordx4 v62, s[52:55], s71 offen nt lds
    s_add_u32 m0, m0, 1024
    s_nop 0
    buffer_load_dwordx4 v63, s[52:55], s71 offen nt lds
    s_add_u32 m0, m0, 1024
    s_nop 0
    buffer_load_dwordx4 v64, s[52:55], s71 offen nt lds
    s_add_u32 m0, m0, 1024
    s_add_u32 s71, s71, 40960
    s_nop 0
    buffer_load_dwordx4 v60, s[52:55], s71 offen nt lds
    s_add_u32 m0, m0, 1024
    s_nop 0
    buffer_load_dwordx4 v61, s[52:55], s71 offen nt lds
    s_add_u32 m0, m0, 1024
    s_nop 0
    buffer_load_dwordx4 v62, s[52:55], s71 offen nt lds
    s_add_u32 m0, m0, 1024
    s_nop 0
    buffer_load_dwordx4 v63, s[52:55], s71 offen nt lds
    s_add_u32 m0, m0, 1024
    s_nop 0
    buffer_load_dwordx4 v64, s[52:55], s71 offen nt lds
    s_add_u32 m0, m0, 1024
    s_add_u32 s71, s71, 40960
    s_nop 0
    buffer_load_dwordx4 v60, s[52:55], s71 offen nt lds
    s_add_u32 m0, m0, 1024
    s_nop 0
    buffer_load_dwordx4 v61, s[52:55], s71 offen nt lds
    s_add_u32 m0, m0, 1024
    s_nop 0
    buffer_load_dwordx4 v62, s[52:55], s71 offen nt lds
    s_add_u32 m0, m0, 1024
    s_nop 0
    buffer_load_dwordx4 v63, s[52:55], s71 offen nt lds
    s_add_u32 m0, m0, 1024
    s_nop 0
    buffer_load_dwordx4 v64, s[52:55], s71 offen nt lds
    s_add_u32 m0, m0, 1024
    s_add_u32 s71, s71, 40960
L_pc_now2:
    s_mov_b32 s40, s24
    s_mov_b32 s41, s25
    s_mov_b32 s42, 1966336
    s_mov_b32 s43, 0x20000
    s_mov_b32 s64, 7
    s_lshr_b32 s66, s2, 3
    s_xor_b32 s67, s66, s2
    s_and_b32 s68, s67, 4
    s_lshl_b32 s68, s68, 3
    s_add_u32 s66, s66, s68
    s_mul_i32 s65, s66, 1280
    s_add_u32 s65, s65, 393216
    s_and_b32 s67, s67, 3
    s_cselect_b32 s66, 1000, s66
    s_cmp_ge_u32 s66, 55
    s_cselect_b32 s66, 1000, s66
    s_add_u32 s66, s66, 4
    s_add_u32 s67, s66, 6
    v_sub_u32 v59, s67, v0
    v_cmp_le_u32 vcc, 44, v59
    v_mov_b32 v58, 1
    s_nop 0
    v_cndmask_b32 v58, 3, v58, vcc
    v_and_b32 v59, v58, v59
    v_cmp_eq_u32 vcc, 0, v59
    s_and_b64 s[74:75], vcc, 120
    s_cselect_b32 s66, s66, 1000
    v_sub_u32 v59, 7, v0
    v_mul_u32_u24 v59, 1280, v59
    v_lshl_add_u32 v59, v0, 2, v59
    s_getreg_b32 s16, hwreg(HW_REG_XCC_ID, 0, 3)
    s_lshl_b32 s16, s16, 13
    s_add_u32 s16, s16, 524288
    s_getreg_b32 s17, hwreg(HW_REG_HW_ID, 8, 1)
    s_lshl_b32 s17, s17, 6
    v_lshlrev_b32 v58, 6, v0
    s_lshl_b32 s69, s27, 13
    s_add_u32 s69, s69, 589824
    s_lshl_b32 s67, s60, 2
    v_add_u32 v55, s67, v58
    v_mov_b32 v99, 8576
    s_waitcnt lgkmcnt(0)
    s_barrier
    s_waitcnt vmcnt(0)
    s_barrier
    ds_read_b32 v57, v99 offset:96
    s_waitcnt lgkmcnt(0)
    v_readfirstlane_b32 s61, v57
    s_mov_b64 exec, 0xff
L_pc_loop:
    ds_read_b128 v[8:11], v99 offset:16
    s_waitcnt lgkmcnt(0)
    v_min_u32 v12, v8, v9
    v_min3_u32 v12, v12, v10, v11
    v_max_u32 v8, v8, v9
    v_max3_u32 v8, v8, v10, v11
    v_readfirstlane_b32 s67, v12
    v_readfirstlane_b32 s68, v8
    s_cmp_lt_u32 s67, s66
    s_cbranch_scc1 L_pc_nopub
    s_mov_b32 s66, 1000
    s_mov_b64 exec, s[74:75]
    buffer_store_dword v57, v59, s[40:43], s65 offen sc1
    s_mov_b64 exec, 0xff
L_pc_nopub:
    s_cmp_ge_u32 s67, 59
    s_cbranch_scc1 L_pc_out
    s_cmp_le_u32 s68, s64
    s_cbranch_scc1 L_pc_wait
    s_mov_b32 s64, s68
    s_cmp_ge_u32 s64, 44
    s_cselect_b32 s68, 1, 3
    s_andn2_b32 s68, s64, s68
    s_sub_u32 s68, s68, 3
    s_mul_i32 s68, s68, 1280
    s_add_u32 s68, s68, 393216
    s_load_dwordx8 s[4:11], s[24:25], s68
    s_lshl_b32 s67, s64, 7
    s_add_u32 s67, s67, s16
    s_add_u32 s68, s67, s17
    s_load_dwordx2 s[12:13], s[24:25], s68
    s_mov_b32 s72, 0
    s_cmp_lt_u32 s64, 8
    s_cbranch_scc1 L_pc_nog
    s_lshl_b32 s70, s64, 7
    s_add_u32 s70, s70, s69
    s_add_u32 s68, s70, s17
    s_load_dwordx8 s[28:35], s[24:25], s68
    s_mov_b64 exec, 3
    buffer_store_dword v57, v55, s[40:43], s70 offen
    s_mov_b64 exec, 0xff
    s_waitcnt lgkmcnt(0)
    s_cmp_eq_u32 s28, s61
    s_addc_u32 s72, s72, 0
    s_cmp_eq_u32 s29, s61
    s_addc_u32 s72, s72, 0
    s_cmp_eq_u32 s30, s61
    s_addc_u32 s72, s72, 0
    s_cmp_eq_u32 s31, s61
    s_addc_u32 s72, s72, 0
    s_cmp_eq_u32 s32, s61
    s_addc_u32 s72, s72, 0
    s_cmp_eq_u32 s33, s61
    s_addc_u32 s72, s72, 0
    s_cmp_eq_u32 s34, s61
    s_addc_u32 s72, s72, 0
    s_cmp_eq_u32 s35, s61
    s_addc_u32 s72, s72, 0
    s_cmp_ge_u32 s72, 5
    s_cselect_b32 s72, 1, 0
L_pc_nog:
    s_sub_u32 s68, s64, 4
    s_waitcnt lgkmcnt(0)
    s_cmp_eq_u32 s7, s61
    s_addc_u32 s68, s68, 0
    s_cmp_eq_u32 s8, s61
    s_addc_u32 s68, s68, 0
    s_cmp_eq_u32 s9, s61
    s_addc_u32 s68, s68, 0
    s_cmp_eq_u32 s10, s61
    s_addc_u32 s68, s68, 0
    s_cmp_eq_u32 s13, s61
    s_cselect_b32 s12, s12, 0
    s_cmp_gt_u32 s68, s12
    s_cselect_b32 s68, s68, s12
    v_mov_b32 v8, s68
    v_add_u32 v8, s72, v8
    v_mov_b32 v9, v8
    ds_write2_b64 v99, v[8:9], v[8:9] offset0:0 offset1:1
    s_cbranch_scc0 L_pc_loop
    s_sub_u32 s67, s67, 896
    s_mov_b64 exec, 0xffff
    v_mov_b32 v56, s68
    buffer_store_dwordx2 v[56:57], v58, s[40:43], s67 offen
    s_mov_b64 exec, 0xff
    s_branch L_pc_loop
L_pc_wait:
    s_sleep 2
    s_branch L_pc_loop
L_pc_out:
    s_mov_b64 exec, -1
    s_branch L_vdone
.p2align 3
L_aux:
    v_lshrrev_b32 v1, 4, v0
    v_and_b32 v2, 15, v0
    s_lshl_b32 s65, s65, 6
    s_mov_b32 s40, s24
    s_mov_b32 s41, s25
    s_mov_b32 s42, 1966336
    s_mov_b32 s43, 0x20000
    s_mov_b32 s56, s20
    s_mov_b32 s57, s21
    s_mov_b32 s58, 5120
    s_mov_b32 s59, 0x20000
    s_mov_b32 s74, 0xffff0000
    s_mov_b32 s75, 0
    s_mov_b32 s76, 0
    s_mov_b32 s77, 0xffff
    s_mov_b32 s78, 0
    s_mov_b32 s79, 0xffff0000
    s_mov_b32 s83, 0x3fb8aa3b
    v_mov_b32 v4, 0x3f803f80
    v_mov_b32 v76, 0
    v_mul_u32_u24 v70, 1312, v1
    v_lshl_add_u32 v70, v2, 4, v70
    s_mul_i32 s14, s14, 0x01010101
    s_and_b32 s67, s26, 0xe0
    s_add_u32 s22, s22, s67
    s_addc_u32 s23, s23, 0
    s_waitcnt vmcnt(2)
    v_dot2c_f32_bf16 v76, v8, v4
    v_dot2c_f32_bf16 v76, v9, v4
    v_dot2c_f32_bf16 v76, v10, v4
    v_dot2c_f32_bf16 v76, v11, v4
    v_dot2c_f32_bf16 v76, v12, v4
    v_dot2c_f32_bf16 v76, v13, v4
    v_dot2c_f32_bf16 v76, v14, v4
    v_dot2c_f32_bf16 v76, v15, v4
    v_dot2c_f32_bf16 v76, v16, v4
    v_dot2c_f32_bf16 v76, v17, v4
    v_dot2c_f32_bf16 v76, v18, v4
    v_dot2c_f32_bf16 v76, v19, v4
    v_dot2c_f32_bf16 v76, v20, v4
    v_dot2c_f32_bf16 v76, v21, v4
    v_dot2c_f32_bf16 v76, v22, v4
    v_dot2c_f32_bf16 v76, v23, v4
    v_dot2c_f32_bf16 v76, v24, v4
    v_dot2c_f32_bf16 v76, v25, v4
    v_dot2c_f32_bf16 v76, v26, v4
    v_dot2c_f32_bf16 v76, v27, v4
    v_lshlrev_b32 v28, 16, v8
    v_and_b32 v29, 0xffff0000, v8
    v_lshlrev_b32 v30, 16, v9
    v_and_b32 v31, 0xffff0000, v9
    v_lshlrev_b32 v32, 16, v10
    v_and_b32 v33, 0xffff0000, v10
    v_lshlrev_b32 v34, 16, v11
    v_and_b32 v35, 0xffff0000, v11
    v_lshlrev_b32 v36, 16, v12
    v_and_b32 v37, 0xffff0000, v12
    v_lshlrev_b32 v38, 16, v13
    v_and_b32 v39, 0xffff0000, v13
    v_lshlrev_b32 v40, 16, v14
    v_and_b32 v41, 0xffff0000, v14
    v_lshlrev_b32 v42, 16, v15
    v_and_b32 v43, 0xffff0000, v15
    v_lshlrev_b32 v44, 16, v16
    v_and_b32 v45, 0xffff0000, v16
    v_lshlrev_b32 v46, 16, v17
    v_and_b32 v47, 0xffff0000, v17
    v_lshlrev_b32 v48, 16, v18
    v_and_b32 v49, 0xffff0000, v18
    v_lshlrev_b32 v50, 16, v19
    v_and_b32 v51, 0xffff0000, v19
    v_lshlrev_b32 v52, 16, v20
    v_and_b32 v53, 0xffff0000, v20
    v_lshlrev_b32 v54, 16, v21
    v_and_b32 v55, 0xffff0000, v21
    v_lshlrev_b32 v56, 16, v22
    v_and_b32 v57, 0xffff0000, v22
    v_lshlrev_b32 v58, 16, v23
    v_and_b32 v59, 0xffff0000, v23
    v_lshlrev_b32 v60, 16, v24
    v_and_b32 v61, 0xffff0000, v24
    v_lshlrev_b32 v62, 16, v25
    v_and_b32 v63, 0xffff0000, v25
    v_lshlrev_b32 v64, 16, v26
    v_and_b32 v65, 0xffff0000, v26
    v_lshlrev_b32 v66, 16, v27
    v_and_b32 v67, 0xffff0000, v27
    s_nop 1
    v_add_f32_dpp v76, v76, v76 quad_perm:[1,0,3,2] row_mask:0xf bank_mask:0xf
    s_nop 1
    v_add_f32_dpp v76, v76, v76 quad_perm:[2,3,0,1] row_mask:0xf bank_mask:0xf
    s_nop 1
    v_add_f32_dpp v76, v76, v76 row_half_mirror row_mask:0xf bank_mask:0xf
    s_nop 1
    v_add_f32_dpp v76, v76, v76 row_ror:8 row_mask:0xf bank_mask:0xf
    v_mul_f32 v76, 0x3acccccd, v76
    v_mov_b32 v72, 0
    v_mov_b32 v73, 0
    v_pk_add_f32 v[74:75], v[28:29], v[76:77] op_sel_hi:[1,0] neg_lo:[0,1] neg_hi:[0,1]
    v_pk_fma_f32 v[72:73], v[74:75], v[74:75], v[72:73]
    v_pk_add_f32 v[74:75], v[30:31], v[76:77] op_sel_hi:[1,0] neg_lo:[0,1] neg_hi:[0,1]
    v_pk_fma_f32 v[72:73], v[74:75], v[74:75], v[72:73]
    v_pk_add_f32 v[74:75], v[32:33], v[76:77] op_sel_hi:[1,0] neg_lo:[0,1] neg_hi:[0,1]
    v_pk_fma_f32 v[72:73], v[74:75], v[74:75], v[72:73]
    v_pk_add_f32 v[74:75], v[34:35], v[76:77] op_sel_hi:[1,0] neg_lo:[0,1] neg_hi:[0,1]
    v_pk_fma_f32 v[72:73], v[74:75], v[74:75], v[72:73]
    v_pk_add_f32 v[74:75], v[36:37], v[76:77] op_sel_hi:[1,0] neg_lo:[0,1] neg_hi:[0,1]
    v_pk_fma_f32 v[72:73], v[74:75], v[74:75], v[72:73]
    v_pk_add_f32 v[74:75], v[38:39], v[76:77] op_sel_hi:[1,0] neg_lo:[0,1] neg_hi:[0,1]
    v_pk_fma_f32 v[72:73], v[74:75], v[74:75], v[72:73]
    v_pk_add_f32 v[74:75], v[40:41], v[76:77] op_sel_hi:[1,0] neg_lo:[0,1] neg_hi:[0,1]
    v_pk_fma_f32 v[72:73], v[74:75], v[74:75], v[72:73]
    v_pk_add_f32 v[74:75], v[42:43], v[76:77] op_sel_hi:[1,0] neg_lo:[0,1] neg_hi:[0,1]
    v_pk_fma_f32 v[72:73], v[74:75], v[74:75], v[72:73]
    v_pk_add_f32 v[74:75], v[44:45], v[76:77] op_sel_hi:[1,0] neg_lo:[0,1] neg_hi:[0,1]
    v_pk_fma_f32 v[72:73], v[74:75], v[74:75], v[72:73]
    v_pk_add_f32 v[74:75], v[46:47], v[76:77] op_sel_hi:[1,0] neg_lo:[0,1] neg_hi:[0,1]
    v_pk_fma_f32 v[72:73], v[74:75], v[74:75], v[72:73]
    v_pk_add_f32 v[74:75], v[48:49], v[76:77] op_sel_hi:[1,0] neg_lo:[0,1] neg_hi:[0,1]
    v_pk_fma_f32 v[72:73], v[74:75], v[74:75], v[72:73]
    v_pk_add_f32 v[74:75], v[50:51], v[76:77] op_sel_hi:[1,0] neg_lo:[0,1] neg_hi:[0,1]
    v_pk_fma_f32 v[72:73], v[74:75], v[74:75], v[72:73]
    v_pk_add_f32 v[74:75], v[52:53], v[76:77] op_sel_hi:[1,0] neg_lo:[0,1] neg_hi:[0,1]
    v_pk_fma_f32 v[72:73], v[74:75], v[74:75], v[72:73]
    v_pk_add_f32 v[74:75], v[54:55], v[76:77] op_sel_hi:[1,0] neg_lo:[0,1] neg_hi:[0,1]
    v_pk_fma_f32 v[72:73], v[74:75], v[74:75], v[72:73]
    v_pk_add_f32 v[74:75], v[56:57], v[76:77] op_sel_hi:[1,0] neg_lo:[0,1] neg_hi:[0,1]
    v_pk_fma_f32 v[72:73], v[74:75], v[74:75], v[72:73]
    v_pk_add_f32 v[74:75], v[58:59], v[76:77] op_sel_hi:[1,0] neg_lo:[0,1] neg_hi:[0,1]
    v_pk_fma_f32 v[72:73], v[74:75], v[74:75], v[72:73]
    v_pk_add_f32 v[74:75], v[60:61], v[76:77] op_sel_hi:[1,0] neg_lo:[0,1] neg_hi:[0,1]
    v_pk_fma_f32 v[72:73], v[74:75], v[74:75], v[72:73]
    v_pk_add_f32 v[74:75], v[62:63], v[76:77] op_sel_hi:[1,0] neg_lo:[0,1] neg_hi:[0,1]
    v_pk_fma_f32 v[72:73], v[74:75], v[74:75], v[72:73]
    v_pk_add_f32 v[74:75], v[64:65], v[76:77] op_sel_hi:[1,0] neg_lo:[0,1] neg_hi:[0,1]
    v_pk_fma_f32 v[72:73], v[74:75], v[74:75], v[72:73]
    v_pk_add_f32 v[74:75], v[66:67], v[76:77] op_sel_hi:[1,0] neg_lo:[0,1] neg_hi:[0,1]
    v_pk_fma_f32 v[72:73], v[74:75], v[74:75], v[72:73]
    v_add_f32 v72, v72, v73
    s_nop 1
    v_add_f32_dpp v72, v72, v72 quad_perm:[1,0,3,2] row_mask:0xf bank_mask:0xf
    s_nop 1
    v_add_f32_dpp v72, v72, v72 quad_perm:[2,3,0,1] row_mask:0xf bank_mask:0xf
    s_nop 1
    v_add_f32_dpp v72, v72, v72 row_half_mirror row_mask:0xf bank_mask:0xf
    s_nop 1
    v_add_f32_dpp v72, v72, v72 row_ror:8 row_mask:0xf bank_mask:0xf
    v_mul_f32 v72, 0x3acccccd, v72
    v_cvt_pk_bf16_f32 v72, 0, v72
    v_add_f32 v72, 0x3727c5ac, v72
    v_cvt_pk_bf16_f32 v72, 0, v72
    v_sqrt_f32 v72, v72
    v_cvt_pk_bf16_f32 v76, 0, v76
    v_cvt_pk_bf16_f32 v72, 0, v72
    v_rcp_f32 v72, v72
    s_load_dwordx8 s[4:11], s[22:23], 0
    v_pk_add_f32 v[28:29], v[28:29], v[76:77] op_sel_hi:[1,0] neg_lo:[0,1] neg_hi:[0,1]
    v_cvt_pk_bf16_f32 v8, v28, v29
    v_pk_add_f32 v[30:31], v[30:31], v[76:77] op_sel_hi:[1,0] neg_lo:[0,1] neg_hi:[0,1]
    v_cvt_pk_bf16_f32 v9, v30, v31
    v_pk_add_f32 v[32:33], v[32:33], v[76:77] op_sel_hi:[1,0] neg_lo:[0,1] neg_hi:[0,1]
    v_cvt_pk_bf16_f32 v10, v32, v33
    v_pk_add_f32 v[34:35], v[34:35], v[76:77] op_sel_hi:[1,0] neg_lo:[0,1] neg_hi:[0,1]
    v_cvt_pk_bf16_f32 v11, v34, v35
    v_pk_add_f32 v[36:37], v[36:37], v[76:77] op_sel_hi:[1,0] neg_lo:[0,1] neg_hi:[0,1]
    v_cvt_pk_bf16_f32 v12, v36, v37
    v_pk_add_f32 v[38:39], v[38:39], v[76:77] op_sel_hi:[1,0] neg_lo:[0,1] neg_hi:[0,1]
    v_cvt_pk_bf16_f32 v13, v38, v39
    v_pk_add_f32 v[40:41], v[40:41], v[76:77] op_sel_hi:[1,0] neg_lo:[0,1] neg_hi:[0,1]
    v_cvt_pk_bf16_f32 v14, v40, v41
    v_pk_add_f32 v[42:43], v[42:43], v[76:77] op_sel_hi:[1,0] neg_lo:[0,1] neg_hi:[0,1]
    v_cvt_pk_bf16_f32 v15, v42, v43
    v_pk_add_f32 v[44:45], v[44:45], v[76:77] op_sel_hi:[1,0] neg_lo:[0,1] neg_hi:[0,1]
    v_cvt_pk_bf16_f32 v16, v44, v45
    v_pk_add_f32 v[46:47], v[46:47], v[76:77] op_sel_hi:[1,0] neg_lo:[0,1] neg_hi:[0,1]
    v_cvt_pk_bf16_f32 v17, v46, v47
    v_pk_add_f32 v[48:49], v[48:49], v[76:77] op_sel_hi:[1,0] neg_lo:[0,1] neg_hi:[0,1]
    v_cvt_pk_bf16_f32 v18, v48, v49
    v_pk_add_f32 v[50:51], v[50:51], v[76:77] op_sel_hi:[1,0] neg_lo:[0,1] neg_hi:[0,1]
    v_cvt_pk_bf16_f32 v19, v50, v51
    v_pk_add_f32 v[52:53], v[52:53], v[76:77] op_sel_hi:[1,0] neg_lo:[0,1] neg_hi:[0,1]
    v_cvt_pk_bf16_f32 v20, v52, v53
    v_pk_add_f32 v[54:55], v[54:55], v[76:77] op_sel_hi:[1,0] neg_lo:[0,1] neg_hi:[0,1]
    v_cvt_pk_bf16_f32 v21, v54, v55
    v_pk_add_f32 v[56:57], v[56:57], v[76:77] op_sel_hi:[1,0] neg_lo:[0,1] neg_hi:[0,1]
    v_cvt_pk_bf16_f32 v22, v56, v57
    v_pk_add_f32 v[58:59], v[58:59], v[76:77] op_sel_hi:[1,0] neg_lo:[0,1] neg_hi:[0,1]
    v_cvt_pk_bf16_f32 v23, v58, v59
    v_pk_add_f32 v[60:61], v[60:61], v[76:77] op_sel_hi:[1,0] neg_lo:[0,1] neg_hi:[0,1]
    v_cvt_pk_bf16_f32 v24, v60, v61
    v_pk_add_f32 v[62:63], v[62:63], v[76:77] op_sel_hi:[1,0] neg_lo:[0,1] neg_hi:[0,1]
    v_cvt_pk_bf16_f32 v25, v62, v63
    v_pk_add_f32 v[64:65], v[64:65], v[76:77] op_sel_hi:[1,0] neg_lo:[0,1] neg_hi:[0,1]
    v_cvt_pk_bf16_f32 v26, v64, v65
    v_pk_add_f32 v[66:67], v[66:67], v[76:77] op_sel_hi:[1,0] neg_lo:[0,1] neg_hi:[0,1]
    v_cvt_pk_bf16_f32 v27, v66, v67
    v_lshlrev_b32 v28, 16, v8
    v_and_b32 v29, 0xffff0000, v8
    v_pk_mul_f32 v[28:29], v[28:29], v[72:73] op_sel_hi:[1,0]
    v_cvt_pk_bf16_f32 v8, v28, v29
    v_lshlrev_b32 v30, 16, v9
    v_and_b32 v31, 0xffff0000, v9
    v_pk_mul_f32 v[30:31], v[30:31], v[72:73] op_sel_hi:[1,0]
    v_cvt_pk_bf16_f32 v9, v30, v31
    v_lshlrev_b32 v32, 16, v10
    v_and_b32 v33, 0xffff0000, v10
    v_pk_mul_f32 v[32:33], v[32:33], v[72:73] op_sel_hi:[1,0]
    v_cvt_pk_bf16_f32 v10, v32, v33
    v_lshlrev_b32 v34, 16, v11
    v_and_b32 v35, 0xffff0000, v11
    v_pk_mul_f32 v[34:35], v[34:35], v[72:73] op_sel_hi:[1,0]
    v_cvt_pk_bf16_f32 v11, v34, v35
    ds_write_b128 v70, v[8:11] offset:0
    v_lshlrev_b32 v36, 16, v12
    v_and_b32 v37, 0xffff0000, v12
    v_pk_mul_f32 v[36:37], v[36:37], v[72:73] op_sel_hi:[1,0]
    v_cvt_pk_bf16_f32 v12, v36, v37
    v_lshlrev_b32 v38, 16, v13
    v_and_b32 v39, 0xffff0000, v13
    v_pk_mul_f32 v[38:39], v[38:39], v[72:73] op_sel_hi:[1,0]
    v_cvt_pk_bf16_f32 v13, v38, v39
    v_lshlrev_b32 v40, 16, v14
    v_and_b32 v41, 0xffff0000, v14
    v_pk_mul_f32 v[40:41], v[40:41], v[72:73] op_sel_hi:[1,0]
    v_cvt_pk_bf16_f32 v14, v40, v41
    v_lshlrev_b32 v42, 16, v15
    v_and_b32 v43, 0xffff0000, v15
    v_pk_mul_f32 v[42:43], v[42:43], v[72:73] op_sel_hi:[1,0]
    v_cvt_pk_bf16_f32 v15, v42, v43
    ds_write_b128 v70, v[12:15] offset:256
    v_lshlrev_b32 v44, 16, v16
    v_and_b32 v45, 0xffff0000, v16
    v_pk_mul_f32 v[44:45], v[44:45], v[72:73] op_sel_hi:[1,0]
    v_cvt_pk_bf16_f32 v16, v44, v45
    v_lshlrev_b32 v46, 16, v17
    v_and_b32 v47, 0xffff0000, v17
    v_pk_mul_f32 v[46:47], v[46:47], v[72:73] op_sel_hi:[1,0]
    v_cvt_pk_bf16_f32 v17, v46, v47
    v_lshlrev_b32 v48, 16, v18
    v_and_b32 v49, 0xffff0000, v18
    v_pk_mul_f32 v[48:49], v[48:49], v[72:73] op_sel_hi:[1,0]
    v_cvt_pk_bf16_f32 v18, v48, v49
    v_lshlrev_b32 v50, 16, v19
    v_and_b32 v51, 0xffff0000, v19
    v_pk_mul_f32 v[50:51], v[50:51], v[72:73] op_sel_hi:[1,0]
    v_cvt_pk_bf16_f32 v19, v50, v51
    ds_write_b128 v70, v[16:19] offset:512
    v_lshlrev_b32 v52, 16, v20
    v_and_b32 v53, 0xffff0000, v20
    v_pk_mul_f32 v[52:53], v[52:53], v[72:73] op_sel_hi:[1,0]
    v_cvt_pk_bf16_f32 v20, v52, v53
    v_lshlrev_b32 v54, 16, v21
    v_and_b32 v55, 0xffff0000, v21
    v_pk_mul_f32 v[54:55], v[54:55], v[72:73] op_sel_hi:[1,0]
    v_cvt_pk_bf16_f32 v21, v54, v55
    v_lshlrev_b32 v56, 16, v22
    v_and_b32 v57, 0xffff0000, v22
    v_pk_mul_f32 v[56:57], v[56:57], v[72:73] op_sel_hi:[1,0]
    v_cvt_pk_bf16_f32 v22, v56, v57
    v_lshlrev_b32 v58, 16, v23
    v_and_b32 v59, 0xffff0000, v23
    v_pk_mul_f32 v[58:59], v[58:59], v[72:73] op_sel_hi:[1,0]
    v_cvt_pk_bf16_f32 v23, v58, v59
    ds_write_b128 v70, v[20:23] offset:768
    v_lshlrev_b32 v60, 16, v24
    v_and_b32 v61, 0xffff0000, v24
    v_pk_mul_f32 v[60:61], v[60:61], v[72:73] op_sel_hi:[1,0]
    v_cvt_pk_bf16_f32 v24, v60, v61
    v_lshlrev_b32 v62, 16, v25
    v_and_b32 v63, 0xffff0000, v25
    v_pk_mul_f32 v[62:63], v[62:63], v[72:73] op_sel_hi:[1,0]
    v_cvt_pk_bf16_f32 v25, v62, v63
    v_lshlrev_b32 v64, 16, v26
    v_and_b32 v65, 0xffff0000, v26
    v_pk_mul_f32 v[64:65], v[64:65], v[72:73] op_sel_hi:[1,0]
    v_cvt_pk_bf16_f32 v26, v64, v65
    v_lshlrev_b32 v66, 16, v27
    v_and_b32 v67, 0xffff0000, v27
    v_pk_mul_f32 v[66:67], v[66:67], v[72:73] op_sel_hi:[1,0]
    v_cvt_pk_bf16_f32 v27, v66, v67
    ds_write_b128 v70, v[24:27] offset:1024
    v_and_b32 v3, 3, v0
    v_mul_u32_u24 v71, 1312, v3
    v_lshl_add_u32 v71, v1, 3, v71
    s_mul_i32 s67, s64, 640
    v_add_u32 v71, s67, v71
    s_waitcnt vmcnt(0) lgkmcnt(0)
    v_readlane_b32 s61, v100, 0
    v_and_b32 v100, 15, v100
    v_lshlrev_b32 v100, v100, 1
    v_and_b32 v101, 15, v101
    v_lshlrev_b32 v101, v101, 1
    v_and_b32 v102, 15, v102
    v_lshlrev_b32 v102, v102, 1
    v_and_b32 v103, 15, v103
    v_lshlrev_b32 v103, v103, 1
    v_or3_b32 v100, v100, v101, v102
    v_or_b32 v100, v100, v103
    s_mul_i32 s61, s61, 0x9e3779b1
    s_add_u32 s61, s61, 0x7f4a7c15
    v_readlane_b32 s67, v100, 0
    v_readlane_b32 s68, v100, 1
    s_and_b32 s69, s61, 15
    s_or_b32 s67, s67, s68
    s_mul_i32 s67, s67, 0x10001
    s_lshr_b32 s67, s67, s69
    s_ff0_i32_b32 s67, s67
    s_add_u32 s67, s67, s69
    s_and_b32 s67, s67, 15
    s_andn2_b32 s61, s61, 15
    s_or_b32 s61, s61, s67
    ds_read2_b64 v[28:31], v71 offset0:0 offset1:4
    ds_read2_b64 v[32:35], v71 offset0:8 offset1:12
    ds_read2_b64 v[36:39], v71 offset0:16 offset1:20
    ds_read2_b64 v[40:43], v71 offset0:24 offset1:28
    ds_read2_b64 v[44:47], v71 offset0:32 offset1:36
    ds_read2_b64 v[48:51], v71 offset0:40 offset1:44
    ds_read2_b64 v[52:55], v71 offset0:48 offset1:52
    ds_read2_b64 v[56:59], v71 offset0:56 offset1:60
    ds_read2_b64 v[60:63], v71 offset0:64 offset1:68
    ds_read2_b64 v[64:67], v71 offset0:72 offset1:76
    v_lshrrev_b32 v68, 2, v0
    v_lshlrev_b32 v68, 7, v68
    v_lshl_add_u32 v68, v3, 3, v68
    v_bfe_u32 v69, v0, 3, 2
    v_xor_b32 v72, 0, v69
    v_lshl_add_u32 v4, v72, 5, v68
    v_xor_b32 v72, 1, v69
    v_lshl_add_u32 v5, v72, 5, v68
    v_xor_b32 v72, 2, v69
    v_lshl_add_u32 v6, v72, 5, v68
    v_xor_b32 v72, 3, v69
    v_lshl_add_u32 v7, v72, 5, v68
    s_waitcnt lgkmcnt(0)
    s_xor_b32 s4, s4, s14
    s_xor_b32 s5, s5, s14
    s_xor_b32 s6, s6, s14
    s_xor_b32 s7, s7, s14
    s_xor_b32 s8, s8, s14
    s_xor_b32 s9, s9, s14
    s_xor_b32 s10, s10, s14
    s_xor_b32 s11, s11, s14
    s_or_b64 s[4:5], s[4:5], s[6:7]
    s_or_b64 s[4:5], s[4:5], s[8:9]
    s_or_b64 s[4:5], s[4:5], s[10:11]
    s_cselect_b32 s15, 0, 1
    s_mul_i32 s67, s64, 30720
    s_add_u32 s67, s67, s65
    s_lshl_b32 s67, s67, 2
    s_add_u32 s71, s67, 4096
    s_barrier
    ds_read_b64_tr_b16 v[72:73], v4 offset:16896
    ds_read_b64_tr_b16 v[74:75], v4 offset:18944
    ds_read_b64_tr_b16 v[76:77], v5 offset:16896
    ds_read_b64_tr_b16 v[78:79], v5 offset:18944
    ds_read_b64_tr_b16 v[80:81], v6 offset:16896
    ds_read_b64_tr_b16 v[82:83], v6 offset:18944
    ds_read_b64_tr_b16 v[84:85], v7 offset:16896
    ds_read_b64_tr_b16 v[86:87], v7 offset:18944
    ds_read_b64_tr_b16 v[88:89], v4 offset:20992
    ds_read_b64_tr_b16 v[90:91], v4 offset:23040
    ds_read_b64_tr_b16 v[92:93], v5 offset:20992
    ds_read_b64_tr_b16 v[94:95], v5 offset:23040
    s_waitcnt lgkmcnt(8)
    v_mfma_f32_16x16x32_bf16 v[8:11], v[28:31], v[72:75], 0
    v_mfma_f32_16x16x32_bf16 v[12:15], v[28:31], v[76:79], 0
    ds_read_b64_tr_b16 v[72:73], v6 offset:20992
    ds_read_b64_tr_b16 v[74:75], v6 offset:23040
    ds_read_b64_tr_b16 v[76:77], v7 offset:20992
    ds_read_b64_tr_b16 v[78:79], v7 offset:23040
    s_waitcnt lgkmcnt(8)
    v_mfma_f32_16x16x32_bf16 v[16:19], v[28:31], v[80:83], 0
    v_mfma_f32_16x16x32_bf16 v[20:23], v[28:31], v[84:87], 0
    ds_read_b64_tr_b16 v[80:81], v4 offset:25088
    ds_read_b64_tr_b16 v[82:83], v4 offset:27136
    ds_read_b64_tr_b16 v[84:85], v5 offset:25088
    ds_read_b64_tr_b16 v[86:87], v5 offset:27136
    s_waitcnt lgkmcnt(8)
    v_mfma_f32_16x16x32_bf16 v[8:11], v[32:35], v[88:91], v[8:11]
    v_mfma_f32_16x16x32_bf16 v[12:15], v[32:35], v[92:95], v[12:15]
    ds_read_b64_tr_b16 v[88:89], v6 offset:25088
    ds_read_b64_tr_b16 v[90:91], v6 offset:27136
    ds_read_b64_tr_b16 v[92:93], v7 offset:25088
    ds_read_b64_tr_b16 v[94:95], v7 offset:27136
    s_waitcnt lgkmcnt(8)
    v_mfma_f32_16x16x32_bf16 v[16:19], v[32:35], v[72:75], v[16:19]
    v_mfma_f32_16x16x32_bf16 v[20:23], v[32:35], v[76:79], v[20:23]
    ds_read_b64_tr_b16 v[72:73], v4 offset:29184
    ds_read_b64_tr_b16 v[74:75], v4 offset:31232
    ds_read_b64_tr_b16 v[76:77], v5 offset:29184
    ds_read_b64_tr_b16 v[78:79], v5 offset:31232
    s_waitcnt lgkmcnt(8)
    v_mfma_f32_16x16x32_bf16 v[8:11], v[36:39], v[80:83], v[8:11]
    v_mfma_f32_16x16x32_bf16 v[12:15], v[36:39], v[84:87], v[12:15]
    ds_read_b64_tr_b16 v[80:81], v6 offset:29184
    ds_read_b64_tr_b16 v[82:83], v6 offset:31232
    ds_read_b64_tr_b16 v[84:85], v7 offset:29184
    ds_read_b64_tr_b16 v[86:87], v7 offset:31232
    s_waitcnt lgkmcnt(8)
    v_mfma_f32_16x16x32_bf16 v[16:19], v[36:39], v[88:91], v[16:19]
    v_mfma_f32_16x16x32_bf16 v[20:23], v[36:39], v[92:95], v[20:23]
    ds_read_b64_tr_b16 v[88:89], v4 offset:33280
    ds_read_b64_tr_b16 v[90:91], v4 offset:35328
    ds_read_b64_tr_b16 v[92:93], v5 offset:33280
    ds_read_b64_tr_b16 v[94:95], v5 offset:35328
    s_waitcnt lgkmcnt(8)
    v_mfma_f32_16x16x32_bf16 v[8:11], v[40:43], v[72:75], v[8:11]
    v_mfma_f32_16x16x32_bf16 v[12:15], v[40:43], v[76:79], v[12:15]
    ds_read_b64_tr_b16 v[72:73], v6 offset:33280
    ds_read_b64_tr_b16 v[74:75], v6 offset:35328
    ds_read_b64_tr_b16 v[76:77], v7 offset:33280
    ds_read_b64_tr_b16 v[78:79], v7 offset:35328
    s_waitcnt lgkmcnt(8)
    v_mfma_f32_16x16x32_bf16 v[16:19], v[40:43], v[80:83], v[16:19]
    v_mfma_f32_16x16x32_bf16 v[20:23], v[40:43], v[84:87], v[20:23]
    ds_read_b64_tr_b16 v[80:81], v4 offset:37376
    ds_read_b64_tr_b16 v[82:83], v4 offset:39424
    ds_read_b64_tr_b16 v[84:85], v5 offset:37376
    ds_read_b64_tr_b16 v[86:87], v5 offset:39424
    s_waitcnt lgkmcnt(8)
    v_mfma_f32_16x16x32_bf16 v[8:11], v[44:47], v[88:91], v[8:11]
    v_mfma_f32_16x16x32_bf16 v[12:15], v[44:47], v[92:95], v[12:15]
    ds_read_b64_tr_b16 v[88:89], v6 offset:37376
    ds_read_b64_tr_b16 v[90:91], v6 offset:39424
    ds_read_b64_tr_b16 v[92:93], v7 offset:37376
    ds_read_b64_tr_b16 v[94:95], v7 offset:39424
    s_waitcnt lgkmcnt(8)
    v_mfma_f32_16x16x32_bf16 v[16:19], v[44:47], v[72:75], v[16:19]
    v_mfma_f32_16x16x32_bf16 v[20:23], v[44:47], v[76:79], v[20:23]
    ds_read_b64_tr_b16 v[72:73], v4 offset:41472
    ds_read_b64_tr_b16 v[74:75], v4 offset:43520
    ds_read_b64_tr_b16 v[76:77], v5 offset:41472
    ds_read_b64_tr_b16 v[78:79], v5 offset:43520
    s_waitcnt lgkmcnt(8)
    v_mfma_f32_16x16x32_bf16 v[8:11], v[48:51], v[80:83], v[8:11]
    v_mfma_f32_16x16x32_bf16 v[12:15], v[48:51], v[84:87], v[12:15]
    ds_read_b64_tr_b16 v[80:81], v6 offset:41472
    ds_read_b64_tr_b16 v[82:83], v6 offset:43520
    ds_read_b64_tr_b16 v[84:85], v7 offset:41472
    ds_read_b64_tr_b16 v[86:87], v7 offset:43520
    s_waitcnt lgkmcnt(8)
    v_mfma_f32_16x16x32_bf16 v[16:19], v[48:51], v[88:91], v[16:19]
    v_mfma_f32_16x16x32_bf16 v[20:23], v[48:51], v[92:95], v[20:23]
    ds_read_b64_tr_b16 v[88:89], v4 offset:45568
    ds_read_b64_tr_b16 v[90:91], v4 offset:47616
    ds_read_b64_tr_b16 v[92:93], v5 offset:45568
    ds_read_b64_tr_b16 v[94:95], v5 offset:47616
    s_waitcnt lgkmcnt(8)
    v_mfma_f32_16x16x32_bf16 v[8:11], v[52:55], v[72:75], v[8:11]
    v_mfma_f32_16x16x32_bf16 v[12:15], v[52:55], v[76:79], v[12:15]
    ds_read_b64_tr_b16 v[72:73], v6 offset:45568
    ds_read_b64_tr_b16 v[74:75], v6 offset:47616
    ds_read_b64_tr_b16 v[76:77], v7 offset:45568
    ds_read_b64_tr_b16 v[78:79], v7 offset:47616
    s_waitcnt lgkmcnt(8)
    v_mfma_f32_16x16x32_bf16 v[16:19], v[52:55], v[80:83], v[16:19]
    v_mfma_f32_16x16x32_bf16 v[20:23], v[52:55], v[84:87], v[20:23]
    ds_read_b64_tr_b16 v[80:81], v4 offset:49664
    ds_read_b64_tr_b16 v[82:83], v4 offset:51712
    ds_read_b64_tr_b16 v[84:85], v5 offset:49664
    ds_read_b64_tr_b16 v[86:87], v5 offset:51712
    s_waitcnt lgkmcnt(8)
    v_mfma_f32_16x16x32_bf16 v[8:11], v[56:59], v[88:91], v[8:11]
    v_mfma_f32_16x16x32_bf16 v[12:15], v[56:59], v[92:95], v[12:15]
    ds_read_b64_tr_b16 v[88:89], v6 offset:49664
    ds_read_b64_tr_b16 v[90:91], v6 offset:51712
    ds_read_b64_tr_b16 v[92:93], v7 offset:49664
    ds_read_b64_tr_b16 v[94:95], v7 offset:51712
    s_waitcnt lgkmcnt(8)
    v_mfma_f32_16x16x32_bf16 v[16:19], v[56:59], v[72:75], v[16:19]
    v_mfma_f32_16x16x32_bf16 v[20:23], v[56:59], v[76:79], v[20:23]
    ds_read_b64_tr_b16 v[72:73], v4 offset:53760
    ds_read_b64_tr_b16 v[74:75], v4 offset:55808
    ds_read_b64_tr_b16 v[76:77], v5 offset:53760
    ds_read_b64_tr_b16 v[78:79], v5 offset:55808
    s_waitcnt lgkmcnt(8)
    v_mfma_f32_16x16x32_bf16 v[8:11], v[60:63], v[80:83], v[8:11]
    v_mfma_f32_16x16x32_bf16 v[12:15], v[60:63], v[84:87], v[12:15]
    ds_read_b64_tr_b16 v[80:81], v6 offset:53760
    ds_read_b64_tr_b16 v[82:83], v6 offset:55808
    ds_read_b64_tr_b16 v[84:85], v7 offset:53760
    ds_read_b64_tr_b16 v[86:87], v7 offset:55808
    s_waitcnt lgkmcnt(8)
    v_mfma_f32_16x16x32_bf16 v[16:19], v[60:63], v[88:91], v[16:19]
    v_mfma_f32_16x16x32_bf16 v[20:23], v[60:63], v[92:95], v[20:23]
    s_waitcnt lgkmcnt(4)
    v_mfma_f32_16x16x32_bf16 v[8:11], v[64:67], v[72:75], v[8:11]
    v_mfma_f32_16x16x32_bf16 v[12:15], v[64:67], v[76:79], v[12:15]
    s_waitcnt lgkmcnt(0)
    v_mfma_f32_16x16x32_bf16 v[16:19], v[64:67], v[80:83], v[16:19]
    v_mfma_f32_16x16x32_bf16 v[20:23], v[64:67], v[84:87], v[20:23]
    s_nop 0
    s_and_b32 s19, s61, 15
    v_lshlrev_b32 v70, 3, v0
    v_lshlrev_b32 v66, 2, v0
    v_mov_b32 v28, s61
    v_mov_b32 v29, 15
    s_cmp_eq_u32 s66, 0
    s_cbranch_scc1 L_nopub
    v_cndmask_b32 v24, v8, v12, s[74:75]
    v_cndmask_b32 v24, v24, v16, s[76:77]
    v_cndmask_b32 v24, v24, v20, s[78:79]
    v_bfi_b32 v24, v29, v28, v24
    v_cndmask_b32 v25, v9, v13, s[74:75]
    v_cndmask_b32 v25, v25, v17, s[76:77]
    v_cndmask_b32 v25, v25, v21, s[78:79]
    v_bfi_b32 v25, v29, v28, v25
    v_cndmask_b32 v26, v10, v14, s[74:75]
    v_cndmask_b32 v26, v26, v18, s[76:77]
    v_cndmask_b32 v26, v26, v22, s[78:79]
    v_bfi_b32 v26, v29, v28, v26
    v_cndmask_b32 v27, v11, v15, s[74:75]
    v_cndmask_b32 v27, v27, v19, s[76:77]
    v_cndmask_b32 v27, v27, v23, s[78:79]
    v_bfi_b32 v27, v29, v28, v27
    s_cmp_lg_u32 s15, 0
    s_cbranch_scc1 L_rh_113
    v_and_b32 v2, 7, v0
    v_lshlrev_b32 v2, 2, v2
    global_load_dword v3, v2, s[22:23] sc1
    s_waitcnt vmcnt(0)
    v_cmp_ne_u32 vcc, s14, v3
    s_cmp_eq_u64 vcc, 0
    s_cselect_b32 s15, 1, 0
L_rh_113:
    s_cmp_eq_u32 s15, 0
    s_cbranch_scc1 L_qslow
    buffer_store_dword v24, v66, s[40:43], s71 offen
    s_add_u32 s71, s71, 30720
    buffer_store_dword v25, v66, s[40:43], s71 offen
    s_add_u32 s71, s71, 30720
    buffer_store_dword v26, v66, s[40:43], s71 offen
    s_add_u32 s71, s71, 30720
    buffer_store_dword v27, v66, s[40:43], s71 offen
    s_add_u32 s71, s71, 30720
    s_branch L_nopub
L_qslow:
    buffer_store_dword v24, v66, s[40:43], s71 offen sc1
    s_add_u32 s71, s71, 30720
    buffer_store_dword v25, v66, s[40:43], s71 offen sc1
    s_add_u32 s71, s71, 30720
    buffer_store_dword v26, v66, s[40:43], s71 offen sc1
    s_add_u32 s71, s71, 30720
    buffer_store_dword v27, v66, s[40:43], s71 offen sc1
    s_add_u32 s71, s71, 30720
L_nopub:
    v_lshlrev_b32 v69, 5, v0
    v_lshlrev_b32 v94, 4, v0
    s_mul_i32 s71, s27, 768
    s_add_u32 s71, s71, 4096
    v_mov_b32 v99, 8576
    v_mov_b32 v32, 0
    v_mov_b32 v33, 0
    ds_write2_b64 v99, v[32:33], v[32:33] offset0:0 offset1:1
    ds_write2_b64 v99, v[32:33], v[32:33] offset0:2 offset1:3
    ds_write2_b64 v99, v[32:33], v[32:33] offset0:4 offset1:5
    ds_write2_b64 v99, v[32:33], v[32:33] offset0:6 offset1:7
    ds_write2_b64 v99, v[32:33], v[32:33] offset0:8 offset1:9
    ds_write2_b64 v99, v[32:33], v[32:33] offset0:10 offset1:11
    ds_write_b32 v99, v28 offset:96
    s_add_u32 s5, s71, 30720
    s_add_u32 s6, s71, 61440
    s_add_u32 s7, s71, 92160
    s_add_u32 s8, s71, 122880
    s_add_u32 s9, s71, 153600
    s_add_u32 s10, s71, 184320
    s_add_u32 s11, s71, 215040
    s_mov_b32 exec_hi, 0xffff
    s_mov_b32 s73, 200000
L_g4_114:
    buffer_load_dwordx4 v[100:103], v94, s[40:43], s71 offen sc1
    buffer_load_dwordx4 v[104:107], v94, s[40:43], s5 offen sc1
    buffer_load_dwordx4 v[108:111], v94, s[40:43], s6 offen sc1
    buffer_load_dwordx4 v[112:115], v94, s[40:43], s7 offen sc1
    buffer_load_dwordx4 v[116:119], v94, s[40:43], s8 offen sc1
    buffer_load_dwordx4 v[120:123], v94, s[40:43], s9 offen sc1
    buffer_load_dwordx4 v[124:127], v94, s[40:43], s10 offen sc1
    buffer_load_dwordx4 v[128:131], v94, s[40:43], s11 offen sc1
    s_sub_u32 s73, s73, 1
    s_waitcnt vmcnt(0)
    v_xor_b32 v100, s19, v100
    v_xor_b32 v101, s19, v101
    v_xor_b32 v102, s19, v102
    v_xor_b32 v103, s19, v103
    v_xor_b32 v104, s19, v104
    v_xor_b32 v105, s19, v105
    v_xor_b32 v106, s19, v106
    v_xor_b32 v107, s19, v107
    v_xor_b32 v108, s19, v108
    v_xor_b32 v109, s19, v109
    v_xor_b32 v110, s19, v110
    v_xor_b32 v111, s19, v111
    v_xor_b32 v112, s19, v112
    v_xor_b32 v113, s19, v113
    v_xor_b32 v114, s19, v114
    v_xor_b32 v115, s19, v115
    v_xor_b32 v116, s19, v116
    v_xor_b32 v117, s19, v117
    v_xor_b32 v118, s19, v118
    v_xor_b32 v119, s19, v119
    v_xor_b32 v120, s19, v120
    v_xor_b32 v121, s19, v121
    v_xor_b32 v122, s19, v122
    v_xor_b32 v123, s19, v123
    v_xor_b32 v124, s19, v124
    v_xor_b32 v125, s19, v125
    v_xor_b32 v126, s19, v126
    v_xor_b32 v127, s19, v127
    v_xor_b32 v128, s19, v128
    v_xor_b32 v129, s19, v129
    v_xor_b32 v130, s19, v130
    v_xor_b32 v131, s19, v131
    v_or_b32 v2, v100, v101
    v_or3_b32 v2, v2, v102, v103
    v_or3_b32 v2, v2, v104, v105
    v_or3_b32 v2, v2, v106, v107
    v_or3_b32 v2, v2, v108, v109
    v_or3_b32 v2, v2, v110, v111
    v_or3_b32 v2, v2, v112, v113
    v_or3_b32 v2, v2, v114, v115
    v_or3_b32 v2, v2, v116, v117
    v_or3_b32 v2, v2, v118, v119
    v_or3_b32 v2, v2, v120, v121
    v_or3_b32 v2, v2, v122, v123
    v_or3_b32 v2, v2, v124, v125
    v_or3_b32 v2, v2, v126, v127
    v_or3_b32 v2, v2, v128, v129
    v_or3_b32 v2, v2, v130, v131
    s_nop 1
    v_or_b32_dpp v2, v2, v2 quad_perm:[1,0,3,2] row_mask:0xf bank_mask:0xf
    s_cbranch_scc1 L_g4x_115
    s_nop 0
    v_or_b32_dpp v2, v2, v2 quad_perm:[2,3,0,1] row_mask:0xf bank_mask:0xf
    v_and_b32 v2, 15, v2
    v_cmp_ne_u32 vcc, 0, v2
    s_and_b64 exec, exec, vcc
    s_cbranch_execnz L_g4_114
L_g4x_115:
    s_mov_b32 exec_lo, -1
    s_mov_b32 exec_hi, 0xffff
    v_pk_add_f32 v[100:101], v[100:101], v[116:117]
    v_pk_add_f32 v[102:103], v[102:103], v[118:119]
    v_cvt_pk_bf16_f32 v100, v100, v101
    v_cvt_pk_bf16_f32 v101, v102, v103
    ds_write_b64 v70, v[100:101] offset:6912
    v_pk_add_f32 v[104:105], v[104:105], v[120:121]
    v_pk_add_f32 v[106:107], v[106:107], v[122:123]
    v_cvt_pk_bf16_f32 v104, v104, v105
    v_cvt_pk_bf16_f32 v105, v106, v107
    ds_write_b64 v70, v[104:105] offset:7328
    v_pk_add_f32 v[108:109], v[108:109], v[124:125]
    v_pk_add_f32 v[110:111], v[110:111], v[126:127]
    v_cvt_pk_bf16_f32 v108, v108, v109
    v_cvt_pk_bf16_f32 v109, v110, v111
    ds_write_b64 v70, v[108:109] offset:7744
    v_pk_add_f32 v[112:113], v[112:113], v[128:129]
    v_pk_add_f32 v[114:115], v[114:115], v[130:131]
    v_cvt_pk_bf16_f32 v112, v112, v113
    v_cvt_pk_bf16_f32 v113, v114, v115
    ds_write_b64 v70, v[112:113] offset:8160
    s_mov_b64 exec, -1
    s_waitcnt lgkmcnt(0)
    s_barrier
    v_lshrrev_b32 v2, 2, v0
    v_mul_u32_u24 v2, 160, v2
    v_and_b32 v3, 3, v0
    v_lshl_add_u32 v65, v3, 3, v2
    v_add_u32 v65, 88576, v65
    s_cmp_lt_u32 s60, 6
    s_cbranch_scc1 L_noffn2
    s_lshl_b32 s69, s27, 1
    s_add_u32 s69, s69, s60
    s_sub_u32 s69, s69, 6
    s_lshr_b32 s70, s69, 3
    s_and_b32 s69, s69, 7
    s_mul_i32 s71, s70, 768
    s_add_u32 s71, s71, 28672
    s_add_u32 s5, s71, 30720
    s_add_u32 s6, s71, 61440
    s_add_u32 s7, s71, 92160
    s_add_u32 s8, s71, 122880
    s_add_u32 s9, s71, 153600
    s_add_u32 s10, s71, 184320
    s_add_u32 s11, s71, 215040
    s_mov_b32 exec_hi, 0xffff
    s_mov_b32 s73, 200000
L_g4_116:
    buffer_load_dwordx4 v[100:103], v94, s[40:43], s71 offen sc1
    buffer_load_dwordx4 v[104:107], v94, s[40:43], s5 offen sc1
    buffer_load_dwordx4 v[108:111], v94, s[40:43], s6 offen sc1
    buffer_load_dwordx4 v[112:115], v94, s[40:43], s7 offen sc1
    buffer_load_dwordx4 v[116:119], v94, s[40:43], s8 offen sc1
    buffer_load_dwordx4 v[120:123], v94, s[40:43], s9 offen sc1
    buffer_load_dwordx4 v[124:127], v94, s[40:43], s10 offen sc1
    buffer_load_dwordx4 v[128:131], v94, s[40:43], s11 offen sc1
    s_sub_u32 s73, s73, 1
    s_waitcnt vmcnt(0)
    v_xor_b32 v100, s19, v100
    v_xor_b32 v101, s19, v101
    v_xor_b32 v102, s19, v102
    v_xor_b32 v103, s19, v103
    v_xor_b32 v104, s19, v104
    v_xor_b32 v105, s19, v105
    v_xor_b32 v106, s19, v106
    v_xor_b32 v107, s19, v107
    v_xor_b32 v108, s19, v108
    v_xor_b32 v109, s19, v109
    v_xor_b32 v110, s19, v110
    v_xor_b32 v111, s19, v111
    v_xor_b32 v112, s19, v112
    v_xor_b32 v113, s19, v113
    v_xor_b32 v114, s19, v114
    v_xor_b32 v115, s19, v115
    v_xor_b32 v116, s19, v116
    v_xor_b32 v117, s19, v117
    v_xor_b32 v118, s19, v118
    v_xor_b32 v119, s19, v119
    v_xor_b32 v120, s19, v120
    v_xor_b32 v121, s19, v121
    v_xor_b32 v122, s19, v122
    v_xor_b32 v123, s19, v123
    v_xor_b32 v124, s19, v124
    v_xor_b32 v125, s19, v125
    v_xor_b32 v126, s19, v126
    v_xor_b32 v127, s19, v127
    v_xor_b32 v128, s19, v128
    v_xor_b32 v129, s19, v129
    v_xor_b32 v130, s19, v130
    v_xor_b32 v131, s19, v131
    v_or_b32 v2, v100, v101
    v_or3_b32 v2, v2, v102, v103
    v_or3_b32 v2, v2, v104, v105
    v_or3_b32 v2, v2, v106, v107
    v_or3_b32 v2, v2, v108, v109
    v_or3_b32 v2, v2, v110, v111
    v_or3_b32 v2, v2, v112, v113
    v_or3_b32 v2, v2, v114, v115
    v_or3_b32 v2, v2, v116, v117
    v_or3_b32 v2, v2, v118, v119
    v_or3_b32 v2, v2, v120, v121
    v_or3_b32 v2, v2, v122, v123
    v_or3_b32 v2, v2, v124, v125
    v_or3_b32 v2, v2, v126, v127
    v_or3_b32 v2, v2, v128, v129
    v_or3_b32 v2, v2, v130, v131
    s_nop 1
    v_or_b32_dpp v2, v2, v2 quad_perm:[1,0,3,2] row_mask:0xf bank_mask:0xf
    s_cbranch_scc1 L_g4x_117
    s_nop 0
    v_or_b32_dpp v2, v2, v2 quad_perm:[2,3,0,1] row_mask:0xf bank_mask:0xf
    v_and_b32 v2, 15, v2
    v_cmp_ne_u32 vcc, 0, v2
    s_and_b64 exec, exec, vcc
    s_cbranch_execz L_g4x_117
    s_sleep 4
    s_branch L_g4_116
L_g4x_117:
    s_mov_b32 exec_lo, -1
    s_mov_b32 exec_hi, 0xffff
    v_pk_add_f32 v[100:101], v[100:101], v[116:117]
    v_pk_add_f32 v[102:103], v[102:103], v[118:119]
    v_max_f32 v100, 0, v100
    v_max_f32 v101, 0, v101
    v_max_f32 v102, 0, v102
    v_max_f32 v103, 0, v103
    v_cvt_pk_bf16_f32 v100, v100, v101
    v_cvt_pk_bf16_f32 v101, v102, v103
    ds_write_b64 v70, v[100:101] offset:5248
    v_pk_add_f32 v[104:105], v[104:105], v[120:121]
    v_pk_add_f32 v[106:107], v[106:107], v[122:123]
    v_max_f32 v104, 0, v104
    v_max_f32 v105, 0, v105
    v_max_f32 v106, 0, v106
    v_max_f32 v107, 0, v107
    v_cvt_pk_bf16_f32 v104, v104, v105
    v_cvt_pk_bf16_f32 v105, v106, v107
    ds_write_b64 v70, v[104:105] offset:5664
    v_pk_add_f32 v[108:109], v[108:109], v[124:125]
    v_pk_add_f32 v[110:111], v[110:111], v[126:127]
    v_max_f32 v108, 0, v108
    v_max_f32 v109, 0, v109
    v_max_f32 v110, 0, v110
    v_max_f32 v111, 0, v111
    v_cvt_pk_bf16_f32 v108, v108, v109
    v_cvt_pk_bf16_f32 v109, v110, v111
    ds_write_b64 v70, v[108:109] offset:6080
    v_pk_add_f32 v[112:113], v[112:113], v[128:129]
    v_pk_add_f32 v[114:115], v[114:115], v[130:131]
    v_max_f32 v112, 0, v112
    v_max_f32 v113, 0, v113
    v_max_f32 v114, 0, v114
    v_max_f32 v115, 0, v115
    v_cvt_pk_bf16_f32 v112, v112, v113
    v_cvt_pk_bf16_f32 v113, v114, v115
    ds_write_b64 v70, v[112:113] offset:6496
    s_mov_b64 exec, -1
    v_and_b32 v3, 3, v0
    v_mul_u32_u24 v71, 416, v3
    v_lshl_add_u32 v71, v1, 3, v71
    v_add_u32 v71, 5248, v71
    s_waitcnt vmcnt(0) lgkmcnt(0)
    ds_read2_b64 v[28:31], v71 offset0:0 offset1:4
    ds_read2_b64 v[32:35], v71 offset0:8 offset1:12
    ds_read2_b64 v[36:39], v71 offset0:16 offset1:20
    ds_read2_b64 v[40:43], v71 offset0:24 offset1:28
    ds_read2_b64 v[44:47], v71 offset0:32 offset1:36
    ds_read2_b64 v[48:51], v71 offset0:40 offset1:44
    s_waitcnt lgkmcnt(0)
    ds_read_b64_tr_b16 v[100:101], v65 offset:0
    ds_read_b64_tr_b16 v[102:103], v65 offset:2560
    ds_read_b64_tr_b16 v[120:121], v65 offset:5120
    ds_read_b64_tr_b16 v[122:123], v65 offset:7680
    ds_read_b64_tr_b16 v[140:141], v65 offset:10240
    ds_read_b64_tr_b16 v[142:143], v65 offset:12800
    ds_read_b64_tr_b16 v[160:161], v65 offset:15360
    ds_read_b64_tr_b16 v[162:163], v65 offset:17920
    ds_read_b64_tr_b16 v[180:181], v65 offset:20480
    ds_read_b64_tr_b16 v[182:183], v65 offset:23040
    ds_read_b64_tr_b16 v[200:201], v65 offset:25600
    ds_read_b64_tr_b16 v[202:203], v65 offset:28160
    ds_read_b64_tr_b16 v[104:105], v65 offset:32
    ds_read_b64_tr_b16 v[106:107], v65 offset:2592
    ds_read_b64_tr_b16 v[124:125], v65 offset:5152
    s_waitcnt lgkmcnt(14)
    ds_read_b64_tr_b16 v[126:127], v65 offset:7712
    s_waitcnt lgkmcnt(14)
    ds_read_b64_tr_b16 v[144:145], v65 offset:10272
    s_waitcnt lgkmcnt(14)
    ds_read_b64_tr_b16 v[146:147], v65 offset:12832
    s_waitcnt lgkmcnt(14)
    ds_read_b64_tr_b16 v[164:165], v65 offset:15392
    s_waitcnt lgkmcnt(14)
    ds_read_b64_tr_b16 v[166:167], v65 offset:17952
    s_waitcnt lgkmcnt(14)
    ds_read_b64_tr_b16 v[184:185], v65 offset:20512
    s_waitcnt lgkmcnt(14)
    ds_read_b64_tr_b16 v[186:187], v65 offset:23072
    s_waitcnt lgkmcnt(14)
    ds_read_b64_tr_b16 v[204:205], v65 offset:25632
    s_waitcnt lgkmcnt(14)
    ds_read_b64_tr_b16 v[206:207], v65 offset:28192
    s_waitcnt lgkmcnt(14)
    ds_read_b64_tr_b16 v[108:109], v65 offset:64
    s_waitcnt lgkmcnt(14)
    ds_read_b64_tr_b16 v[110:111], v65 offset:2624
    s_waitcnt lgkmcnt(14)
    ds_read_b64_tr_b16 v[128:129], v65 offset:5184
    s_waitcnt lgkmcnt(14)
    ds_read_b64_tr_b16 v[130:131], v65 offset:7744
    s_waitcnt lgkmcnt(14)
    ds_read_b64_tr_b16 v[148:149], v65 offset:10304
    s_waitcnt lgkmcnt(14)
    ds_read_b64_tr_b16 v[150:151], v65 offset:12864
    s_waitcnt lgkmcnt(14)
    ds_read_b64_tr_b16 v[168:169], v65 offset:15424
    s_waitcnt lgkmcnt(14)
    ds_read_b64_tr_b16 v[170:171], v65 offset:17984
    s_waitcnt lgkmcnt(14)
    ds_read_b64_tr_b16 v[188:189], v65 offset:20544
    s_waitcnt lgkmcnt(14)
    ds_read_b64_tr_b16 v[190:191], v65 offset:23104
    s_waitcnt lgkmcnt(14)
    ds_read_b64_tr_b16 v[208:209], v65 offset:25664
    s_waitcnt lgkmcnt(14)
    ds_read_b64_tr_b16 v[210:211], v65 offset:28224
    s_waitcnt lgkmcnt(14)
    ds_read_b64_tr_b16 v[112:113], v65 offset:96
    s_waitcnt lgkmcnt(14)
    ds_read_b64_tr_b16 v[114:115], v65 offset:2656
    s_waitcnt lgkmcnt(14)
    ds_read_b64_tr_b16 v[132:133], v65 offset:5216
    s_waitcnt lgkmcnt(14)
    ds_read_b64_tr_b16 v[134:135], v65 offset:7776
    s_waitcnt lgkmcnt(14)
    ds_read_b64_tr_b16 v[152:153], v65 offset:10336
    s_waitcnt lgkmcnt(14)
    ds_read_b64_tr_b16 v[154:155], v65 offset:12896
    s_waitcnt lgkmcnt(14)
    ds_read_b64_tr_b16 v[172:173], v65 offset:15456
    s_waitcnt lgkmcnt(14)
    ds_read_b64_tr_b16 v[174:175], v65 offset:18016
    s_waitcnt lgkmcnt(14)
    ds_read_b64_tr_b16 v[192:193], v65 offset:20576
    s_waitcnt lgkmcnt(14)
    ds_read_b64_tr_b16 v[194:195], v65 offset:23136
    s_waitcnt lgkmcnt(14)
    ds_read_b64_tr_b16 v[212:213], v65 offset:25696
    s_waitcnt lgkmcnt(14)
    ds_read_b64_tr_b16 v[214:215], v65 offset:28256
    s_waitcnt lgkmcnt(14)
    ds_read_b64_tr_b16 v[116:117], v65 offset:128
    s_waitcnt lgkmcnt(14)
    ds_read_b64_tr_b16 v[118:119], v65 offset:2688
    s_waitcnt lgkmcnt(14)
    ds_read_b64_tr_b16 v[136:137], v65 offset:5248
    s_waitcnt lgkmcnt(14)
    ds_read_b64_tr_b16 v[138:139], v65 offset:7808
    s_waitcnt lgkmcnt(14)
    ds_read_b64_tr_b16 v[156:157], v65 offset:10368
    s_waitcnt lgkmcnt(14)
    ds_read_b64_tr_b16 v[158:159], v65 offset:12928
    s_waitcnt lgkmcnt(14)
    ds_read_b64_tr_b16 v[176:177], v65 offset:15488
    s_waitcnt lgkmcnt(14)
    ds_read_b64_tr_b16 v[178:179], v65 offset:18048
    s_waitcnt lgkmcnt(14)
    ds_read_b64_tr_b16 v[196:197], v65 offset:20608
    s_waitcnt lgkmcnt(14)
    ds_read_b64_tr_b16 v[198:199], v65 offset:23168
    s_waitcnt lgkmcnt(14)
    ds_read_b64_tr_b16 v[216:217], v65 offset:25728
    s_waitcnt lgkmcnt(14)
    ds_read_b64_tr_b16 v[218:219], v65 offset:28288
    s_waitcnt lgkmcnt(0)
    v_mfma_f32_16x16x32_bf16 v[8:11], v[28:31], v[100:103], 0
    v_mfma_f32_16x16x32_bf16 v[12:15], v[28:31], v[104:107], 0
    v_mfma_f32_16x16x32_bf16 v[16:19], v[28:31], v[108:111], 0
    v_mfma_f32_16x16x32_bf16 v[20:23], v[28:31], v[112:115], 0
    v_mfma_f32_16x16x32_bf16 v[24:27], v[28:31], v[116:119], 0
    v_mfma_f32_16x16x32_bf16 v[8:11], v[32:35], v[120:123], v[8:11]
    v_mfma_f32_16x16x32_bf16 v[12:15], v[32:35], v[124:127], v[12:15]
    v_mfma_f32_16x16x32_bf16 v[16:19], v[32:35], v[128:131], v[16:19]
    v_mfma_f32_16x16x32_bf16 v[20:23], v[32:35], v[132:135], v[20:23]
    v_mfma_f32_16x16x32_bf16 v[24:27], v[32:35], v[136:139], v[24:27]
    v_mfma_f32_16x16x32_bf16 v[8:11], v[36:39], v[140:143], v[8:11]
    v_mfma_f32_16x16x32_bf16 v[12:15], v[36:39], v[144:147], v[12:15]
    v_mfma_f32_16x16x32_bf16 v[16:19], v[36:39], v[148:151], v[16:19]
    v_mfma_f32_16x16x32_bf16 v[20:23], v[36:39], v[152:155], v[20:23]
    v_mfma_f32_16x16x32_bf16 v[24:27], v[36:39], v[156:159], v[24:27]
    v_mfma_f32_16x16x32_bf16 v[8:11], v[40:43], v[160:163], v[8:11]
    v_mfma_f32_16x16x32_bf16 v[12:15], v[40:43], v[164:167], v[12:15]
    v_mfma_f32_16x16x32_bf16 v[16:19], v[40:43], v[168:171], v[16:19]
    v_mfma_f32_16x16x32_bf16 v[20:23], v[40:43], v[172:175], v[20:23]
    v_mfma_f32_16x16x32_bf16 v[24:27], v[40:43], v[176:179], v[24:27]
    v_mfma_f32_16x16x32_bf16 v[8:11], v[44:47], v[180:183], v[8:11]
    v_mfma_f32_16x16x32_bf16 v[12:15], v[44:47], v[184:187], v[12:15]
    v_mfma_f32_16x16x32_bf16 v[16:19], v[44:47], v[188:191], v[16:19]
    v_mfma_f32_16x16x32_bf16 v[20:23], v[44:47], v[192:195], v[20:23]
    v_mfma_f32_16x16x32_bf16 v[24:27], v[44:47], v[196:199], v[24:27]
    v_mfma_f32_16x16x32_bf16 v[8:11], v[48:51], v[200:203], v[8:11]
    v_mfma_f32_16x16x32_bf16 v[12:15], v[48:51], v[204:207], v[12:15]
    v_mfma_f32_16x16x32_bf16 v[16:19], v[48:51], v[208:211], v[16:19]
    v_mfma_f32_16x16x32_bf16 v[20:23], v[48:51], v[212:215], v[20:23]
    v_mfma_f32_16x16x32_bf16 v[24:27], v[48:51], v[216:219], v[24:27]
    s_mul_i32 s71, s70, 10240
    s_mul_i32 s67, s69, 1280
    s_add_u32 s71, s71, s67
    s_add_u32 s71, s71, 262144
    v_mov_b32 v3, 15
    s_nop 7
    v_cndmask_b32 v28, v8, v9, s[74:75]
    v_cndmask_b32 v28, v28, v10, s[76:77]
    v_cndmask_b32 v28, v28, v11, s[78:79]
    v_bfi_b32 v28, v3, s61, v28
    buffer_store_dword v28, v66, s[40:43], s71 offen offset:0 sc1
    v_cndmask_b32 v30, v12, v13, s[74:75]
    v_cndmask_b32 v30, v30, v14, s[76:77]
    v_cndmask_b32 v30, v30, v15, s[78:79]
    v_bfi_b32 v30, v3, s61, v30
    buffer_store_dword v30, v66, s[40:43], s71 offen offset:256 sc1
    v_cndmask_b32 v32, v16, v17, s[74:75]
    v_cndmask_b32 v32, v32, v18, s[76:77]
    v_cndmask_b32 v32, v32, v19, s[78:79]
    v_bfi_b32 v32, v3, s61, v32
    buffer_store_dword v32, v66, s[40:43], s71 offen offset:512 sc1
    v_cndmask_b32 v34, v20, v21, s[74:75]
    v_cndmask_b32 v34, v34, v22, s[76:77]
    v_cndmask_b32 v34, v34, v23, s[78:79]
    v_bfi_b32 v34, v3, s61, v34
    buffer_store_dword v34, v66, s[40:43], s71 offen offset:768 sc1
    v_cndmask_b32 v36, v24, v25, s[74:75]
    v_cndmask_b32 v36, v36, v26, s[76:77]
    v_cndmask_b32 v36, v36, v27, s[78:79]
    v_bfi_b32 v36, v3, s61, v36
    buffer_store_dword v36, v66, s[40:43], s71 offen offset:1024 sc1
L_noffn2:
    s_mul_i32 s67, s27, 5
    s_add_u32 s67, s67, s60
    s_lshl_b32 s63, s67, 6
    s_and_b32 s68, s67, 3
    s_mul_i32 s68, s68, 40
    s_lshr_b32 s67, s67, 2
    s_add_u32 s67, s67, s68
    v_lshrrev_b32 v2, 3, v0
    v_lshlrev_b32 v89, 4, v2
    v_lshrrev_b32 v2, 2, v0
    v_mul_u32_u24 v92, 10240, v2
    v_and_b32 v3, 3, v0
    v_lshl_add_u32 v92, v3, 4, v92
    v_lshl_add_u32 v93, v3, 2, v1
    v_lshlrev_b32 v93, 1, v93
    s_lshl_b32 s67, s67, 5
    v_add_u32 v93, s67, v93
    v_mov_b32 v87, v94
    v_lshlrev_b32 v88, 7, v1
    v_mov_b32 v41, s61
    v_mov_b32 v43, s61
    s_cmp_ge_u32 s60, 5
    s_cbranch_scc1 L_nogate
    s_mov_b32 s18, 20
L_wp_118:
    ds_read_b128 v[8:11], v99 offset:16
    s_waitcnt lgkmcnt(0)
    v_min_u32 v8, v8, v9
    v_min3_u32 v8, v8, v10, v11
    v_cmp_le_u32 vcc, s18, v8
    s_cbranch_vccnz L_wpx_119
    s_sleep 4
    s_branch L_wp_118
L_wpx_119:
    buffer_load_ushort v91, v93, s[44:47], 0 offen
    s_add_u32 s71, s63, 262144
    v_mov_b32 v8, 0
    v_mov_b32 v9, 0
    v_mov_b32 v10, 0
    v_mov_b32 v11, 0
    s_mov_b32 exec_hi, 0
    s_mov_b32 s73, 200000
L_fp_120:
    buffer_load_dwordx4 v[12:15], v92, s[40:43], s71 offen sc1
    s_sub_u32 s73, s73, 1
    s_waitcnt vmcnt(0)
    v_xor_b32 v8, s19, v12
    v_xor_b32 v9, s19, v13
    v_xor_b32 v10, s19, v14
    v_xor_b32 v11, s19, v15
    v_or3_b32 v2, v8, v9, v10
    v_or_b32 v2, v2, v11
    s_nop 1
    v_or_b32_dpp v2, v2, v2 quad_perm:[1,0,3,2] row_mask:0xf bank_mask:0xf
    s_cbranch_scc1 L_fpx_121
    s_nop 0
    v_or_b32_dpp v2, v2, v2 quad_perm:[2,3,0,1] row_mask:0xf bank_mask:0xf
    v_and_b32 v2, 15, v2
    v_cmp_ne_u32 vcc, 0, v2
    s_and_b64 exec, exec, vcc
    s_cbranch_execz L_fpx_121
    s_sleep 8
    s_branch L_fp_120
L_fpx_121:
    s_mov_b64 exec, -1
    s_nop 1
    v_permlane32_swap_b32 v8, v10
    v_permlane32_swap_b32 v9, v11
    v_add_f32 v8, v8, v10
    v_add_f32 v9, v9, v11
    s_nop 1
    v_permlane16_swap_b32 v8, v9
    v_add_f32 v8, v8, v9
    s_nop 1
    v_add_f32_dpp v8, v8, v8 row_ror:8 row_mask:0xf bank_mask:0xf
    s_nop 1
    v_add_f32_dpp v8, v8, v8 row_ror:4 row_mask:0xf bank_mask:0xf
    v_cvt_pk_bf16_f32 v8, 0, v8
    v_mul_f32 v9, s83, v8
    v_exp_f32 v9, -v9
    v_lshlrev_b32 v91, 16, v91
    v_add_f32 v9, 1.0, v9
    v_rcp_f32 v9, v9
    s_nop 0
    v_mul_f32 v8, v8, v9
    v_cvt_pk_bf16_f32 v90, 0, v8
L_nogate:
    s_cmp_lg_u32 s15, 0
    s_cbranch_scc1 L_rh_122
    v_and_b32 v2, 7, v0
    v_lshlrev_b32 v2, 2, v2
    global_load_dword v3, v2, s[22:23] sc1
    s_waitcnt vmcnt(0)
    v_cmp_ne_u32 vcc, s14, v3
    s_cmp_eq_u64 vcc, 0
    s_cselect_b32 s15, 1, 0
L_rh_122:
    s_mov_b32 s18, 24
    s_lshl_b32 s70, s27, 9
    s_add_u32 s70, s70, 360448
    s_lshl_b32 s69, s60, 4
    s_add_u32 s69, s69, s70
    s_mov_b32 s74, 0x00010001
    s_mov_b32 s75, 0x00000001
    s_mov_b32 s76, 0x00ffffff
    s_mov_b32 s77, 0
L_stats:
L_wp_123:
    ds_read_b128 v[8:11], v99 offset:16
    s_waitcnt lgkmcnt(0)
    v_min_u32 v8, v8, v9
    v_min3_u32 v8, v8, v10, v11
    v_cmp_le_u32 vcc, s18, v8
    s_cbranch_vccnz L_wpx_124
    s_sleep 4
    s_branch L_wp_123
L_wpx_124:
    ds_read_b128 v[8:11], v69 offset:8704
    ds_read_b128 v[12:15], v69 offset:8720
    ds_read_b128 v[16:19], v69 offset:10752
    ds_read_b128 v[20:23], v69 offset:10768
    ds_read_b128 v[24:27], v69 offset:12800
    ds_read_b128 v[28:31], v69 offset:12816
    ds_read_b128 v[32:35], v69 offset:14848
    ds_read_b128 v[36:39], v69 offset:14864
    s_waitcnt lgkmcnt(0)
    v_max_f32 v40, v8, v9
    v_max3_f32 v40, v40, v10, v11
    v_max3_f32 v40, v40, v12, v13
    v_max3_f32 v40, v40, v14, v15
    v_max3_f32 v40, v40, v16, v17
    v_max3_f32 v40, v40, v18, v19
    v_max3_f32 v40, v40, v20, v21
    v_max3_f32 v40, v40, v22, v23
    v_max3_f32 v40, v40, v24, v25
    v_max3_f32 v40, v40, v26, v27
    v_max3_f32 v40, v40, v28, v29
    v_max3_f32 v40, v40, v30, v31
    v_max3_f32 v40, v40, v32, v33
    v_max3_f32 v40, v40, v34, v35
    v_max3_f32 v40, v40, v36, v37
    v_max3_f32 v40, v40, v38, v39
    s_nop 1
    v_max_f32_dpp v40, v40, v40 quad_perm:[1,0,3,2] row_mask:0xf bank_mask:0xf
    s_nop 1
    v_max_f32_dpp v40, v40, v40 quad_perm:[2,3,0,1] row_mask:0xf bank_mask:0xf
    s_nop 1
    v_max_f32_dpp v40, v40, v40 row_half_mirror row_mask:0xf bank_mask:0xf
    s_nop 1
    v_max_f32_dpp v40, v40, v40 row_ror:8 row_mask:0xf bank_mask:0xf
    v_sub_f32 v8, v8, v40
    v_sub_f32 v9, v9, v40
    v_sub_f32 v10, v10, v40
    v_sub_f32 v11, v11, v40
    v_sub_f32 v12, v12, v40
    v_sub_f32 v13, v13, v40
    v_sub_f32 v14, v14, v40
    v_sub_f32 v15, v15, v40
    v_sub_f32 v16, v16, v40
    v_sub_f32 v17, v17, v40
    v_sub_f32 v18, v18, v40
    v_sub_f32 v19, v19, v40
    v_sub_f32 v20, v20, v40
    v_sub_f32 v21, v21, v40
    v_sub_f32 v22, v22, v40
    v_sub_f32 v23, v23, v40
    v_sub_f32 v24, v24, v40
    v_sub_f32 v25, v25, v40
    v_sub_f32 v26, v26, v40
    v_sub_f32 v27, v27, v40
    v_sub_f32 v28, v28, v40
    v_sub_f32 v29, v29, v40
    v_sub_f32 v30, v30, v40
    v_sub_f32 v31, v31, v40
    v_sub_f32 v32, v32, v40
    v_sub_f32 v33, v33, v40
    v_sub_f32 v34, v34, v40
    v_sub_f32 v35, v35, v40
    v_sub_f32 v36, v36, v40
    v_sub_f32 v37, v37, v40
    v_sub_f32 v38, v38, v40
    v_sub_f32 v39, v39, v40
    v_exp_f32 v8, v8
    v_exp_f32 v9, v9
    v_exp_f32 v10, v10
    v_exp_f32 v11, v11
    v_exp_f32 v12, v12
    v_exp_f32 v13, v13
    v_exp_f32 v14, v14
    v_exp_f32 v15, v15
    v_exp_f32 v16, v16
    v_exp_f32 v17, v17
    v_exp_f32 v18, v18
    v_exp_f32 v19, v19
    v_exp_f32 v20, v20
    v_exp_f32 v21, v21
    v_exp_f32 v22, v22
    v_exp_f32 v23, v23
    v_exp_f32 v24, v24
    v_exp_f32 v25, v25
    v_exp_f32 v26, v26
    v_exp_f32 v27, v27
    v_exp_f32 v28, v28
    v_exp_f32 v29, v29
    v_exp_f32 v30, v30
    v_exp_f32 v31, v31
    v_exp_f32 v32, v32
    v_exp_f32 v33, v33
    v_exp_f32 v34, v34
    v_exp_f32 v35, v35
    v_exp_f32 v36, v36
    v_exp_f32 v37, v37
    v_exp_f32 v38, v38
    v_exp_f32 v39, v39
    v_add_f32 v42, v8, v9
    v_add_f32 v42, v42, v10
    v_add_f32 v42, v42, v11
    v_add_f32 v42, v42, v12
    v_add_f32 v42, v42, v13
    v_add_f32 v42, v42, v14
    v_add_f32 v42, v42, v15
    v_add_f32 v42, v42, v16
    v_add_f32 v42, v42, v17
    v_add_f32 v42, v42, v18
    v_add_f32 v42, v42, v19
    v_add_f32 v42, v42, v20
    v_add_f32 v42, v42, v21
    v_add_f32 v42, v42, v22
    v_add_f32 v42, v42, v23
    v_add_f32 v42, v42, v24
    v_add_f32 v42, v42, v25
    v_add_f32 v42, v42, v26
    v_add_f32 v42, v42, v27
    v_add_f32 v42, v42, v28
    v_add_f32 v42, v42, v29
    v_add_f32 v42, v42, v30
    v_add_f32 v42, v42, v31
    v_add_f32 v42, v42, v32
    v_add_f32 v42, v42, v33
    v_add_f32 v42, v42, v34
    v_add_f32 v42, v42, v35
    v_add_f32 v42, v42, v36
    v_add_f32 v42, v42, v37
    v_add_f32 v42, v42, v38
    v_add_f32 v42, v42, v39
    s_nop 1
    v_add_f32_dpp v42, v42, v42 quad_perm:[1,0,3,2] row_mask:0xf bank_mask:0xf
    s_nop 1
    v_add_f32_dpp v42, v42, v42 quad_perm:[2,3,0,1] row_mask:0xf bank_mask:0xf
    s_nop 1
    v_add_f32_dpp v42, v42, v42 row_half_mirror row_mask:0xf bank_mask:0xf
    s_nop 1
    v_add_f32_dpp v42, v42, v42 row_ror:8 row_mask:0xf bank_mask:0xf
    s_mov_b64 exec, s[74:75]
    s_cmp_eq_u32 s15, 0
    s_cbranch_scc1 L_sl_125
    buffer_store_dwordx4 v[40:43], v88, s[40:43], s69 offen
    s_branch L_sd_126
L_sl_125:
    buffer_store_dwordx4 v[40:43], v88, s[40:43], s69 offen sc1
L_sd_126:
    s_mov_b64 exec, -1
    s_add_u32 s18, s18, 3
L_wp_127:
    ds_read_b128 v[8:11], v99 offset:16
    s_waitcnt lgkmcnt(0)
    v_min_u32 v8, v8, v9
    v_min3_u32 v8, v8, v10, v11
    v_cmp_le_u32 vcc, s18, v8
    s_cbranch_vccnz L_wpx_128
    s_sleep 4
    s_branch L_wp_127
L_wpx_128:
    s_mov_b64 exec, s[76:77]
    s_mov_b32 s73, 200000
L_poll_129:
    buffer_load_dwordx4 v[44:47], v94, s[40:43], s70 offen sc1
L_poll1_131:
    s_sub_u32 s73, s73, 1
    s_waitcnt vmcnt(0)
    s_cbranch_scc1 L_pollx_130
    v_xor_b32 v2, s61, v45
    v_bitop3_b32 v2, v2, v47, s61 bitop3:0xf6
    v_cmp_ne_u32 vcc, 0, v2
    s_and_b64 exec, exec, vcc
    s_cbranch_execz L_pollx_130
    s_sleep 4
    s_branch L_poll_129
L_pollx_130:
    s_mov_b64 exec, -1
    v_max_f32_dpp v48, v44, v44 quad_perm:[1,0,3,2] row_mask:0xf bank_mask:0xf
    s_nop 1
    v_max_f32_dpp v48, v48, v48 quad_perm:[2,3,0,1] row_mask:0xf bank_mask:0xf
    s_nop 1
    v_max_f32_dpp v48, v48, v48 row_half_mirror row_mask:0xf bank_mask:0xf
    v_sub_f32 v44, v44, v48
    v_exp_f32 v44, v44
    s_nop 0
    v_mul_f32 v44, v44, v46
    s_nop 1
    v_add_f32_dpp v44, v44, v44 quad_perm:[1,0,3,2] row_mask:0xf bank_mask:0xf
    s_nop 1
    v_add_f32_dpp v44, v44, v44 quad_perm:[2,3,0,1] row_mask:0xf bank_mask:0xf
    s_nop 1
    v_add_f32_dpp v44, v44, v44 row_half_mirror row_mask:0xf bank_mask:0xf
    v_log_f32 v49, v44
    v_mov_b32 v50, 1
    s_mov_b64 exec, s[76:77]
    ds_write_b64 v89, v[48:49] offset:8608
    ds_write_b32 v89, v50 offset:8616
    s_mov_b64 exec, -1
    s_mov_b32 s74, 0
    s_mov_b32 s75, 0x00010000
    s_mov_b32 s76, 0xff000000
    s_add_u32 s18, s18, 5
    s_cmp_lt_u32 s18, 40
    s_cbranch_scc1 L_stats
    s_mul_i32 s70, s27, 24576
    s_add_u32 s70, s70, 1179648
    s_mul_i32 s69, s60, 768
    s_add_u32 s69, s69, s70
    v_lshrrev_b32 v2, 3, v0
    v_and_b32 v3, 7, v0
    v_mul_u32_u24 v85, 768, v2
    v_lshl_add_u32 v85, v3, 4, v85
    v_and_b32 v3, 3, v0
    v_bfe_u32 v4, v0, 2, 1
    v_lshl_add_u32 v3, v3, 1, v4
    v_lshl_add_u32 v84, v2, 3, v3
    v_lshlrev_b32 v84, 3, v84
    v_lshl_add_u32 v2, v1, 1, v2
    v_mul_u32_u24 v86, 528, v2
    v_lshl_add_u32 v86, v3, 3, v86
    v_add_u32 v86, 29712, v86
L_batch:
L_wp_132:
    ds_read_b128 v[8:11], v99 offset:16
    s_waitcnt lgkmcnt(0)
    v_min_u32 v8, v8, v9
    v_min3_u32 v8, v8, v10, v11
    v_cmp_le_u32 vcc, s18, v8
    s_cbranch_vccnz L_wpx_133
    s_sleep 4
    s_branch L_wp_132
L_wpx_133:
L_publish:
    s_mov_b32 exec_hi, 0xffff
    ds_read_b128 v[8:11], v87 offset:16896
    ds_read_b128 v[12:15], v87 offset:17664
    ds_read_b128 v[16:19], v87 offset:18432
    ds_read_b128 v[20:23], v87 offset:19200
    s_cmp_eq_u32 s15, 0
    s_waitcnt lgkmcnt(2)
    v_pk_add_f32 v[8:9], v[8:9], v[12:13]
    v_pk_add_f32 v[10:11], v[10:11], v[14:15]
    s_waitcnt lgkmcnt(0)
    v_pk_add_f32 v[16:17], v[16:17], v[20:21]
    v_pk_add_f32 v[18:19], v[18:19], v[22:23]
    v_pk_add_f32 v[8:9], v[8:9], v[16:17]
    v_pk_add_f32 v[10:11], v[10:11], v[18:19]
    v_cvt_pk_bf16_f32 v40, v8, v9
    v_cvt_pk_bf16_f32 v42, v10, v11
    s_cbranch_scc1 L_sl_134
    buffer_store_dwordx4 v[40:43], v94, s[40:43], s69 offen
    s_branch L_sd_135
L_sl_134:
    buffer_store_dwordx4 v[40:43], v94, s[40:43], s69 offen sc1
L_sd_135:
    s_mov_b32 exec_hi, -1
    s_cmp_eq_u32 s18, 64
    s_cbranch_scc1 L_last
    s_add_u32 s69, s69, 6144
    v_add_u32 v87, 3072, v87
    s_add_u32 s18, s18, 2
L_wp_136:
    ds_read_b128 v[8:11], v99 offset:16
    s_waitcnt lgkmcnt(0)
    v_min_u32 v8, v8, v9
    v_min3_u32 v8, v8, v10, v11
    v_cmp_le_u32 vcc, s18, v8
    s_cbranch_vccnz L_wpx_137
    s_sleep 4
    s_branch L_wp_136
L_wpx_137:
    s_add_u32 s67, s70, 3072
    s_add_u32 s68, s70, 6144
    s_mov_b32 exec_hi, 0xffff
    s_mov_b32 s73, 200000
L_poll_138:
    buffer_load_dwordx4 v[8:11], v94, s[40:43], s70 offen offset:0 sc1
    buffer_load_dwordx4 v[12:15], v94, s[40:43], s70 offen offset:768 sc1
    buffer_load_dwordx4 v[16:19], v94, s[40:43], s70 offen offset:1536 sc1
    buffer_load_dwordx4 v[20:23], v94, s[40:43], s70 offen offset:2304 sc1
    buffer_load_dwordx4 v[24:27], v94, s[40:43], s67 offen offset:0 sc1
    buffer_load_dwordx4 v[28:31], v94, s[40:43], s67 offen offset:768 sc1
    buffer_load_dwordx4 v[32:35], v94, s[40:43], s67 offen offset:1536 sc1
    buffer_load_dwordx4 v[36:39], v94, s[40:43], s67 offen offset:2304 sc1
L_poll1_140:
    s_sub_u32 s73, s73, 1
    s_waitcnt vmcnt(0)
    s_cbranch_scc1 L_pollx_139
    v_xor_b32 v2, s61, v9
    v_bitop3_b32 v2, v2, v11, s61 bitop3:0xf6
    v_bitop3_b32 v2, v2, v13, s61 bitop3:0xf6
    v_bitop3_b32 v2, v2, v15, s61 bitop3:0xf6
    v_bitop3_b32 v2, v2, v17, s61 bitop3:0xf6
    v_bitop3_b32 v2, v2, v19, s61 bitop3:0xf6
    v_bitop3_b32 v2, v2, v21, s61 bitop3:0xf6
    v_bitop3_b32 v2, v2, v23, s61 bitop3:0xf6
    v_bitop3_b32 v2, v2, v25, s61 bitop3:0xf6
    v_bitop3_b32 v2, v2, v27, s61 bitop3:0xf6
    v_bitop3_b32 v2, v2, v29, s61 bitop3:0xf6
    v_bitop3_b32 v2, v2, v31, s61 bitop3:0xf6
    v_bitop3_b32 v2, v2, v33, s61 bitop3:0xf6
    v_bitop3_b32 v2, v2, v35, s61 bitop3:0xf6
    v_bitop3_b32 v2, v2, v37, s61 bitop3:0xf6
    v_bitop3_b32 v2, v2, v39, s61 bitop3:0xf6
    v_cmp_ne_u32 vcc, 0, v2
    s_and_b64 exec, exec, vcc
    s_cbranch_execz L_pollx_139
    s_sleep 2
    s_branch L_poll_138
L_pollx_139:
    s_mov_b32 exec_lo, -1
    s_mov_b32 exec_hi, 0xffff
    v_and_b32 v9, 0xffff0000, v8
    v_lshlrev_b32 v8, 16, v8
    v_and_b32 v11, 0xffff0000, v10
    v_lshlrev_b32 v10, 16, v10
    v_and_b32 v13, 0xffff0000, v12
    v_lshlrev_b32 v12, 16, v12
    v_and_b32 v15, 0xffff0000, v14
    v_lshlrev_b32 v14, 16, v14
    v_pk_add_f32 v[8:9], v[8:9], v[12:13]
    v_pk_add_f32 v[10:11], v[10:11], v[14:15]
    v_and_b32 v17, 0xffff0000, v16
    v_lshlrev_b32 v16, 16, v16
    v_and_b32 v19, 0xffff0000, v18
    v_lshlrev_b32 v18, 16, v18
    v_pk_add_f32 v[8:9], v[8:9], v[16:17]
    v_pk_add_f32 v[10:11], v[10:11], v[18:19]
    v_and_b32 v21, 0xffff0000, v20
    v_lshlrev_b32 v20, 16, v20
    v_and_b32 v23, 0xffff0000, v22
    v_lshlrev_b32 v22, 16, v22
    v_pk_add_f32 v[8:9], v[8:9], v[20:21]
    v_pk_add_f32 v[10:11], v[10:11], v[22:23]
    v_and_b32 v25, 0xffff0000, v24
    v_lshlrev_b32 v24, 16, v24
    v_and_b32 v27, 0xffff0000, v26
    v_lshlrev_b32 v26, 16, v26
    v_pk_add_f32 v[8:9], v[8:9], v[24:25]
    v_pk_add_f32 v[10:11], v[10:11], v[26:27]
    v_and_b32 v29, 0xffff0000, v28
    v_lshlrev_b32 v28, 16, v28
    v_and_b32 v31, 0xffff0000, v30
    v_lshlrev_b32 v30, 16, v30
    v_pk_add_f32 v[8:9], v[8:9], v[28:29]
    v_pk_add_f32 v[10:11], v[10:11], v[30:31]
    v_and_b32 v33, 0xffff0000, v32
    v_lshlrev_b32 v32, 16, v32
    v_and_b32 v35, 0xffff0000, v34
    v_lshlrev_b32 v34, 16, v34
    v_pk_add_f32 v[8:9], v[8:9], v[32:33]
    v_pk_add_f32 v[10:11], v[10:11], v[34:35]
    v_and_b32 v37, 0xffff0000, v36
    v_lshlrev_b32 v36, 16, v36
    v_and_b32 v39, 0xffff0000, v38
    v_lshlrev_b32 v38, 16, v38
    v_pk_add_f32 v[8:9], v[8:9], v[36:37]
    v_pk_add_f32 v[10:11], v[10:11], v[38:39]
    v_cvt_pk_bf16_f32 v48, v8, v9
    v_cvt_pk_bf16_f32 v49, v10, v11
    ds_write_b64 v84, v[48:49] offset:29184
    s_mov_b32 exec_hi, -1
    v_add_u32 v84, 2112, v84
    s_add_u32 s70, s70, 6144
    s_add_u32 s18, s18, 6
    s_cmp_lt_u32 s18, 64
    s_cbranch_scc1 L_batch
    s_add_u32 s71, s63, 851968
    s_add_u32 s5, s71, 163840
    s_waitcnt lgkmcnt(0)
    s_barrier
    s_branch L_publish
L_last:
    s_mov_b32 s73, 200000
    buffer_load_dwordx4 v[100:103], v85, s[40:43], s70 offen offset:0 sc1
    buffer_load_dwordx4 v[104:107], v85, s[40:43], s70 offen offset:128 sc1
    buffer_load_dwordx4 v[108:111], v85, s[40:43], s70 offen offset:256 sc1
    buffer_load_dwordx4 v[112:115], v85, s[40:43], s70 offen offset:384 sc1
    buffer_load_dwordx4 v[116:119], v85, s[40:43], s70 offen offset:512 sc1
    buffer_load_dwordx4 v[120:123], v85, s[40:43], s70 offen offset:640 sc1
    s_barrier
    buffer_load_dwordx4 v[124:127], v85, s[40:43], s70 offen offset:0 sc1
    buffer_load_dwordx4 v[128:131], v85, s[40:43], s70 offen offset:128 sc1
    buffer_load_dwordx4 v[132:135], v85, s[40:43], s70 offen offset:256 sc1
    buffer_load_dwordx4 v[136:139], v85, s[40:43], s70 offen offset:384 sc1
    buffer_load_dwordx4 v[140:143], v85, s[40:43], s70 offen offset:512 sc1
    buffer_load_dwordx4 v[144:147], v85, s[40:43], s70 offen offset:640 sc1
L_pp_141:
    s_waitcnt vmcnt(6)
    ds_write2_b32 v86, v100, v102 offset0:0 offset1:1
    ds_write2_b32 v86, v104, v106 offset0:16 offset1:17
    ds_write2_b32 v86, v108, v110 offset0:32 offset1:33
    ds_write2_b32 v86, v112, v114 offset0:48 offset1:49
    ds_write2_b32 v86, v116, v118 offset0:64 offset1:65
    ds_write2_b32 v86, v120, v122 offset0:80 offset1:81
    v_xor_b32 v2, s61, v101
    v_bitop3_b32 v2, v2, v103, s61 bitop3:0xf6
    v_bitop3_b32 v2, v2, v105, s61 bitop3:0xf6
    v_bitop3_b32 v2, v2, v107, s61 bitop3:0xf6
    v_bitop3_b32 v2, v2, v109, s61 bitop3:0xf6
    v_bitop3_b32 v2, v2, v111, s61 bitop3:0xf6
    v_bitop3_b32 v2, v2, v113, s61 bitop3:0xf6
    v_bitop3_b32 v2, v2, v115, s61 bitop3:0xf6
    v_bitop3_b32 v2, v2, v117, s61 bitop3:0xf6
    v_bitop3_b32 v2, v2, v119, s61 bitop3:0xf6
    v_bitop3_b32 v2, v2, v121, s61 bitop3:0xf6
    v_bitop3_b32 v2, v2, v123, s61 bitop3:0xf6
    v_cmp_ne_u32 vcc, 0, v2
    s_and_b64 exec, exec, vcc
    s_cbranch_execz L_ppx_142
    buffer_load_dwordx4 v[100:103], v85, s[40:43], s70 offen offset:0 sc1
    buffer_load_dwordx4 v[104:107], v85, s[40:43], s70 offen offset:128 sc1
    buffer_load_dwordx4 v[108:111], v85, s[40:43], s70 offen offset:256 sc1
    buffer_load_dwordx4 v[112:115], v85, s[40:43], s70 offen offset:384 sc1
    buffer_load_dwordx4 v[116:119], v85, s[40:43], s70 offen offset:512 sc1
    buffer_load_dwordx4 v[120:123], v85, s[40:43], s70 offen offset:640 sc1
    s_waitcnt vmcnt(6)
    ds_write2_b32 v86, v124, v126 offset0:0 offset1:1
    ds_write2_b32 v86, v128, v130 offset0:16 offset1:17
    ds_write2_b32 v86, v132, v134 offset0:32 offset1:33
    ds_write2_b32 v86, v136, v138 offset0:48 offset1:49
    ds_write2_b32 v86, v140, v142 offset0:64 offset1:65
    ds_write2_b32 v86, v144, v146 offset0:80 offset1:81
    v_xor_b32 v2, s61, v125
    v_bitop3_b32 v2, v2, v127, s61 bitop3:0xf6
    v_bitop3_b32 v2, v2, v129, s61 bitop3:0xf6
    v_bitop3_b32 v2, v2, v131, s61 bitop3:0xf6
    v_bitop3_b32 v2, v2, v133, s61 bitop3:0xf6
    v_bitop3_b32 v2, v2, v135, s61 bitop3:0xf6
    v_bitop3_b32 v2, v2, v137, s61 bitop3:0xf6
    v_bitop3_b32 v2, v2, v139, s61 bitop3:0xf6
    v_bitop3_b32 v2, v2, v141, s61 bitop3:0xf6
    v_bitop3_b32 v2, v2, v143, s61 bitop3:0xf6
    v_bitop3_b32 v2, v2, v145, s61 bitop3:0xf6
    v_bitop3_b32 v2, v2, v147, s61 bitop3:0xf6
    v_cmp_ne_u32 vcc, 0, v2
    s_and_b64 exec, exec, vcc
    s_cbranch_execz L_ppx_142
    buffer_load_dwordx4 v[124:127], v85, s[40:43], s70 offen offset:0 sc1
    buffer_load_dwordx4 v[128:131], v85, s[40:43], s70 offen offset:128 sc1
    buffer_load_dwordx4 v[132:135], v85, s[40:43], s70 offen offset:256 sc1
    buffer_load_dwordx4 v[136:139], v85, s[40:43], s70 offen offset:384 sc1
    buffer_load_dwordx4 v[140:143], v85, s[40:43], s70 offen offset:512 sc1
    buffer_load_dwordx4 v[144:147], v85, s[40:43], s70 offen offset:640 sc1
    s_sub_u32 s73, s73, 1
    s_cbranch_scc0 L_pp_141
L_ppx_142:
    s_mov_b64 exec, -1
    s_waitcnt lgkmcnt(0)
    s_barrier
    s_cmp_ge_u32 s60, 5
    s_cbranch_scc1 L_fin
    s_barrier
    s_mov_b32 s73, 200000
L_fp_143:
    buffer_load_dwordx4 v[12:15], v92, s[40:43], s71 offen sc1
    buffer_load_dwordx4 v[16:19], v92, s[40:43], s5 offen sc1
    s_sub_u32 s73, s73, 1
    s_waitcnt vmcnt(0)
    v_xor_b32 v12, s19, v12
    v_xor_b32 v13, s19, v13
    v_xor_b32 v14, s19, v14
    v_xor_b32 v15, s19, v15
    v_xor_b32 v16, s19, v16
    v_xor_b32 v17, s19, v17
    v_xor_b32 v18, s19, v18
    v_xor_b32 v19, s19, v19
    v_or3_b32 v2, v12, v13, v14
    v_or3_b32 v2, v2, v15, v16
    v_or3_b32 v2, v2, v17, v18
    v_or_b32 v2, v2, v19
    v_pk_add_f32 v[8:9], v[12:13], v[16:17]
    v_pk_add_f32 v[10:11], v[14:15], v[18:19]
    v_or_b32_dpp v2, v2, v2 quad_perm:[1,0,3,2] row_mask:0xf bank_mask:0xf
    s_cbranch_scc1 L_fpx_144
    s_nop 0
    v_or_b32_dpp v2, v2, v2 quad_perm:[2,3,0,1] row_mask:0xf bank_mask:0xf
    v_and_b32 v2, 15, v2
    v_cmp_ne_u32 vcc, 0, v2
    s_and_b64 exec, exec, vcc
    s_cbranch_execnz L_fp_143
L_fpx_144:
    s_mov_b64 exec, -1
    s_nop 1
    v_permlane32_swap_b32 v8, v10
    v_permlane32_swap_b32 v9, v11
    v_add_f32 v8, v8, v10
    v_add_f32 v9, v9, v11
    s_nop 1
    v_permlane16_swap_b32 v8, v9
    v_add_f32 v8, v8, v9
    s_nop 1
    v_add_f32_dpp v8, v8, v8 row_ror:8 row_mask:0xf bank_mask:0xf
    s_nop 1
    v_add_f32_dpp v8, v8, v8 row_ror:4 row_mask:0xf bank_mask:0xf
    v_cvt_pk_bf16_f32 v8, 0, v8
    v_mul_f32 v8, v8, v90
    v_cvt_pk_bf16_f32 v8, 0, v8
    v_add_f32 v8, v8, v91
    v_cvt_pk_bf16_f32 v8, v8, v8
    s_mov_b32 exec_lo, 0x000f000f
    s_mov_b32 exec_hi, 0x000f000f
    buffer_store_short v8, v93, s[56:59], 0 offen
    s_cmp_lg_u32 s26, 0
    s_cbranch_scc1 L_fin
    s_mov_b64 exec, 3
    v_mov_b32 v40, v41
    v_mov_b32 v42, v41
    buffer_store_dwordx4 v[40:43], v96, s[40:43], 0 offen
L_fin:
L_end:
    s_endpgm
L_codeend:
.section .rodata,"a"
.p2align 6
.amdhsa_kernel recurrent_scan__mha_block_cached__dense_activation_relu__decode_kernel
.amdhsa_next_free_vgpr 220
.amdhsa_next_free_sgpr 102
.amdhsa_accum_offset 220
.amdhsa_group_segment_fixed_size 0
.amdhsa_kernarg_size 88
.amdhsa_user_sgpr_count 2
.amdhsa_user_sgpr_kernarg_segment_ptr 1
.amdhsa_system_sgpr_workgroup_id_x 1
.amdhsa_float_denorm_mode_32 3
.end_amdhsa_kernel
```
